```python
import torch

def _softmax(x, axis=-1):
    return torch.softmax(x, dim=axis)
def _gelu(x):
    return torch.nn.functional.gelu(x, approximate="tanh")
def _silu(x):
    return torch.nn.functional.silu(x)
def _sigmoid(x):
    return torch.sigmoid(x)
def _layernorm(x, axis=-1, eps=1e-5):
    m = x.mean(dim=axis, keepdim=True)
    v = x.var(dim=axis, keepdim=True, unbiased=False)
    return (x - m) / torch.sqrt(v + eps)
def _scatter_add(tgt, idx, src, axis=0):
    return tgt.clone().index_add_(axis, idx, src)
def _segment_sum(src, seg, n):
    out = torch.zeros((n,) + src.shape[1:], dtype=src.dtype)
    return out.index_add_(0, seg, src)
def _pad(x, pw):
    flat = tuple(v for pair in reversed(pw) for v in pair)
    return torch.nn.functional.pad(x, flat)

kernel_name = 'standalone__gqa_softmax__near_ridge'

def setup_inputs():

    _w = (lambda a: (lambda t: t.to(torch.bfloat16) if t.is_floating_point() else t)(torch.as_tensor(a)))
    B, Hq, Hkv, Sq, Sk, D = 16, 32, 8, 288, 512, 128
    return {
        "q": _w((lambda *s: torch.randn(*s, dtype=torch.bfloat16) * 0.8)(B, Hq, Sq, D)),
        "k": _w((lambda *s: torch.randn(*s, dtype=torch.bfloat16) * 0.8)(B, Hkv, Sk, D)),
        "v": _w((lambda *s: torch.randn(*s, dtype=torch.bfloat16) * 0.05)(B, Hkv, Sk, D)),
    }

def reference(q, k, v):
    B, Hq, Sq, D = q.shape
    Hkv = k.shape[1]
    rep = Hq // Hkv
    k = (lambda x, n, axis: torch.repeat_interleave(x, n, dim=axis))(k, rep, axis=1)
    v = (lambda x, n, axis: torch.repeat_interleave(x, n, dim=axis))(v, rep, axis=1)
    scale = D ** -0.5
    scores = torch.einsum("bhqd,bhkd->bhqk", q, k) * scale
    p = _softmax(scores, axis=-1)
    return torch.einsum("bhqk,bhkd->bhqd", p, v)
```

```asm
; @launch grid=(256,1,1) block=(512,1,1) lds=151296
.amdgcn_target "amdgcn-amd-amdhsa--gfx950"
.text
.globl standalone__gqa_softmax__near_ridge_kernel
.p2align 8
.type standalone__gqa_softmax__near_ridge_kernel,@function
standalone__gqa_softmax__near_ridge_kernel:
    s_cmp_ge_u32 s2, 256
    s_cbranch_scc1 L_end
    s_load_dwordx4 s[4:7], s[0:1], 0
    s_load_dwordx4 s[8:11], s[0:1], 16
    v_lshrrev_b32 v1, 6, v0
    v_and_b32 v0, 63, v0
    s_lshr_b32 s3, s2, 4
    s_lshl_b32 s3, s3, 3
    s_and_b32 s30, s2, 7
    s_add_u32 s3, s3, s30
    v_readfirstlane_b32 s24, v1
    s_bfe_u32 s30, s2, 0x10003
    s_lshl_b32 s31, s3, 1
    s_add_u32 s31, s31, s30
    s_mul_i32 s31, s31, 147456
    s_lshl_b32 s32, s3, 17
    s_and_b32 s25, s24, 3
    s_and_b32 s42, s3, 0
    s_lshl_b32 s42, s42, 13
    s_and_b32 s43, s3, 0
    s_mov_b32 s29, 0x3e0293ee
    s_mov_b32 s46, 0x2b800000
    s_mov_b32 s47, 0x53800000
    s_waitcnt lgkmcnt(0)
    s_add_u32 s12, s4, s31
    s_addc_u32 s13, s5, 0
    s_mov_b32 s14, 147456
    s_mov_b32 s15, 0x00020000
    s_add_u32 s20, s10, s31
    s_addc_u32 s21, s11, 0
    s_mov_b32 s22, 147456
    s_mov_b32 s23, 0x00020000
    s_mov_b32 s18, 131072
    s_mov_b32 s19, 0x00020000
    s_cmp_ge_u32 s24, 4
    s_cbranch_scc1 L_pv
    s_add_u32 s16, s6, s32
    s_addc_u32 s17, s7, 0
    v_and_b32 v6, 31, v0
    v_lshrrev_b32 v7, 5, v0
    s_lshl_b32 s40, s25, 15
    s_lshl_b32 s41, s25, 13
    v_lshrrev_b32 v8, 4, v0
    v_and_b32 v9, 15, v0
    v_xor_b32 v9, v9, v8
    v_lshlrev_b32 v9, 4, v9
    v_lshl_add_u32 v16, v8, 8, v9
    v_xor_b32 v17, 64, v16
    v_xor_b32 v18, 128, v16
    v_xor_b32 v19, 192, v16
    s_add_u32 m0, s41, 0
    s_add_u32 s30, s40, 0
    s_xor_b32 s30, s30, s42
    buffer_load_dwordx4 v16, s[16:19], s30 offen offset:0 nt lds
    buffer_load_dwordx4 v17, s[16:19], s30 offen offset:1024 nt lds
    buffer_load_dwordx4 v18, s[16:19], s30 offen offset:2048 nt lds
    buffer_load_dwordx4 v19, s[16:19], s30 offen offset:3072 nt lds
    s_add_u32 m0, s41, 4096
    s_add_u32 s30, s40, 0
    s_xor_b32 s30, s30, s42
    s_add_u32 s30, s30, 4096
    buffer_load_dwordx4 v16, s[16:19], s30 offen offset:0 nt lds
    buffer_load_dwordx4 v17, s[16:19], s30 offen offset:1024 nt lds
    buffer_load_dwordx4 v18, s[16:19], s30 offen offset:2048 nt lds
    buffer_load_dwordx4 v19, s[16:19], s30 offen offset:3072 nt lds
    s_add_u32 m0, s41, 32768
    s_add_u32 s30, s40, 8192
    s_xor_b32 s30, s30, s42
    buffer_load_dwordx4 v16, s[16:19], s30 offen offset:0 nt lds
    buffer_load_dwordx4 v17, s[16:19], s30 offen offset:1024 nt lds
    buffer_load_dwordx4 v18, s[16:19], s30 offen offset:2048 nt lds
    buffer_load_dwordx4 v19, s[16:19], s30 offen offset:3072 nt lds
    s_add_u32 m0, s41, 36864
    s_add_u32 s30, s40, 8192
    s_xor_b32 s30, s30, s42
    s_add_u32 s30, s30, 4096
    buffer_load_dwordx4 v16, s[16:19], s30 offen offset:0 nt lds
    buffer_load_dwordx4 v17, s[16:19], s30 offen offset:1024 nt lds
    buffer_load_dwordx4 v18, s[16:19], s30 offen offset:2048 nt lds
    buffer_load_dwordx4 v19, s[16:19], s30 offen offset:3072 nt lds
    v_and_b32 v9, 15, v6
    v_xor_b32 v9, v9, v7
    v_lshlrev_b32 v9, 4, v9
    v_lshl_add_u32 v9, v6, 8, v9
    v_add_u32 v8, s41, v9
    v_mul_u32_u24 v20, 528, v7
    v_lshl_add_u32 v20, v6, 4, v20
    v_add_u32 v1, 131072, v20
    v_lshlrev_b32 v20, 4, v0
    v_add_u32 v2, s41, v20
    s_lshl_b32 s30, s25, 8
    s_add_u32 s30, s30, 147968
    v_lshlrev_b32 v20, 2, v0
    v_add_u32 v3, s30, v20
    v_xor_b32 v9, 32, v8
    v_xor_b32 v10, 64, v8
    v_xor_b32 v11, 96, v8
    v_xor_b32 v12, 128, v8
    v_xor_b32 v13, 160, v8
    v_xor_b32 v14, 192, v8
    v_xor_b32 v15, 224, v8
    s_waitcnt vmcnt(8)
    ds_read_b128 v[128:131], v8 offset:0
    ds_read_b128 v[132:135], v9 offset:0
    ds_read_b128 v[136:139], v10 offset:0
    ds_read_b128 v[140:143], v11 offset:0
    ds_read_b128 v[144:147], v12 offset:0
    ds_read_b128 v[148:151], v13 offset:0
    ds_read_b128 v[152:155], v14 offset:0
    ds_read_b128 v[156:159], v15 offset:0
    s_waitcnt lgkmcnt(0)
    s_add_u32 m0, s41, 0
    s_add_u32 s30, s40, 16384
    s_xor_b32 s30, s30, s42
    buffer_load_dwordx4 v16, s[16:19], s30 offen offset:0 nt lds
    buffer_load_dwordx4 v17, s[16:19], s30 offen offset:1024 nt lds
    buffer_load_dwordx4 v18, s[16:19], s30 offen offset:2048 nt lds
    buffer_load_dwordx4 v19, s[16:19], s30 offen offset:3072 nt lds
    s_add_u32 m0, s41, 4096
    s_add_u32 s30, s40, 16384
    s_xor_b32 s30, s30, s42
    s_add_u32 s30, s30, 4096
    buffer_load_dwordx4 v16, s[16:19], s30 offen offset:0 nt lds
    buffer_load_dwordx4 v17, s[16:19], s30 offen offset:1024 nt lds
    buffer_load_dwordx4 v18, s[16:19], s30 offen offset:2048 nt lds
    buffer_load_dwordx4 v19, s[16:19], s30 offen offset:3072 nt lds
    v_lshlrev_b32 v6, 16, v128
    v_and_b32 v7, 0xffff0000, v128
    v_mul_f32 v6, s29, v6
    v_mul_f32 v7, s29, v7
    v_cvt_pk_bf16_f32 v128, v6, v7
    v_lshlrev_b32 v6, 16, v129
    v_and_b32 v7, 0xffff0000, v129
    v_mul_f32 v6, s29, v6
    v_mul_f32 v7, s29, v7
    v_cvt_pk_bf16_f32 v129, v6, v7
    v_lshlrev_b32 v6, 16, v130
    v_and_b32 v7, 0xffff0000, v130
    v_mul_f32 v6, s29, v6
    v_mul_f32 v7, s29, v7
    v_cvt_pk_bf16_f32 v130, v6, v7
    v_lshlrev_b32 v6, 16, v131
    v_and_b32 v7, 0xffff0000, v131
    v_mul_f32 v6, s29, v6
    v_mul_f32 v7, s29, v7
    v_cvt_pk_bf16_f32 v131, v6, v7
    v_lshlrev_b32 v6, 16, v132
    v_and_b32 v7, 0xffff0000, v132
    v_mul_f32 v6, s29, v6
    v_mul_f32 v7, s29, v7
    v_cvt_pk_bf16_f32 v132, v6, v7
    v_lshlrev_b32 v6, 16, v133
    v_and_b32 v7, 0xffff0000, v133
    v_mul_f32 v6, s29, v6
    v_mul_f32 v7, s29, v7
    v_cvt_pk_bf16_f32 v133, v6, v7
    v_lshlrev_b32 v6, 16, v134
    v_and_b32 v7, 0xffff0000, v134
    v_mul_f32 v6, s29, v6
    v_mul_f32 v7, s29, v7
    v_cvt_pk_bf16_f32 v134, v6, v7
    v_lshlrev_b32 v6, 16, v135
    v_and_b32 v7, 0xffff0000, v135
    v_mul_f32 v6, s29, v6
    v_mul_f32 v7, s29, v7
    v_cvt_pk_bf16_f32 v135, v6, v7
    v_lshlrev_b32 v6, 16, v136
    v_and_b32 v7, 0xffff0000, v136
    v_mul_f32 v6, s29, v6
    v_mul_f32 v7, s29, v7
    v_cvt_pk_bf16_f32 v136, v6, v7
    v_lshlrev_b32 v6, 16, v137
    v_and_b32 v7, 0xffff0000, v137
    v_mul_f32 v6, s29, v6
    v_mul_f32 v7, s29, v7
    v_cvt_pk_bf16_f32 v137, v6, v7
    v_lshlrev_b32 v6, 16, v138
    v_and_b32 v7, 0xffff0000, v138
    v_mul_f32 v6, s29, v6
    v_mul_f32 v7, s29, v7
    v_cvt_pk_bf16_f32 v138, v6, v7
    v_lshlrev_b32 v6, 16, v139
    v_and_b32 v7, 0xffff0000, v139
    v_mul_f32 v6, s29, v6
    v_mul_f32 v7, s29, v7
    v_cvt_pk_bf16_f32 v139, v6, v7
    v_lshlrev_b32 v6, 16, v140
    v_and_b32 v7, 0xffff0000, v140
    v_mul_f32 v6, s29, v6
    v_mul_f32 v7, s29, v7
    v_cvt_pk_bf16_f32 v140, v6, v7
    v_lshlrev_b32 v6, 16, v141
    v_and_b32 v7, 0xffff0000, v141
    v_mul_f32 v6, s29, v6
    v_mul_f32 v7, s29, v7
    v_cvt_pk_bf16_f32 v141, v6, v7
    v_lshlrev_b32 v6, 16, v142
    v_and_b32 v7, 0xffff0000, v142
    v_mul_f32 v6, s29, v6
    v_mul_f32 v7, s29, v7
    v_cvt_pk_bf16_f32 v142, v6, v7
    v_lshlrev_b32 v6, 16, v143
    v_and_b32 v7, 0xffff0000, v143
    v_mul_f32 v6, s29, v6
    v_mul_f32 v7, s29, v7
    v_cvt_pk_bf16_f32 v143, v6, v7
    v_lshlrev_b32 v6, 16, v144
    v_and_b32 v7, 0xffff0000, v144
    v_mul_f32 v6, s29, v6
    v_mul_f32 v7, s29, v7
    v_cvt_pk_bf16_f32 v144, v6, v7
    v_lshlrev_b32 v6, 16, v145
    v_and_b32 v7, 0xffff0000, v145
    v_mul_f32 v6, s29, v6
    v_mul_f32 v7, s29, v7
    v_cvt_pk_bf16_f32 v145, v6, v7
    v_lshlrev_b32 v6, 16, v146
    v_and_b32 v7, 0xffff0000, v146
    v_mul_f32 v6, s29, v6
    v_mul_f32 v7, s29, v7
    v_cvt_pk_bf16_f32 v146, v6, v7
    v_lshlrev_b32 v6, 16, v147
    v_and_b32 v7, 0xffff0000, v147
    v_mul_f32 v6, s29, v6
    v_mul_f32 v7, s29, v7
    v_cvt_pk_bf16_f32 v147, v6, v7
    v_lshlrev_b32 v6, 16, v148
    v_and_b32 v7, 0xffff0000, v148
    v_mul_f32 v6, s29, v6
    v_mul_f32 v7, s29, v7
    v_cvt_pk_bf16_f32 v148, v6, v7
    v_lshlrev_b32 v6, 16, v149
    v_and_b32 v7, 0xffff0000, v149
    v_mul_f32 v6, s29, v6
    v_mul_f32 v7, s29, v7
    v_cvt_pk_bf16_f32 v149, v6, v7
    v_lshlrev_b32 v6, 16, v150
    v_and_b32 v7, 0xffff0000, v150
    v_mul_f32 v6, s29, v6
    v_mul_f32 v7, s29, v7
    v_cvt_pk_bf16_f32 v150, v6, v7
    v_lshlrev_b32 v6, 16, v151
    v_and_b32 v7, 0xffff0000, v151
    v_mul_f32 v6, s29, v6
    v_mul_f32 v7, s29, v7
    v_cvt_pk_bf16_f32 v151, v6, v7
    v_lshlrev_b32 v6, 16, v152
    v_and_b32 v7, 0xffff0000, v152
    v_mul_f32 v6, s29, v6
    v_mul_f32 v7, s29, v7
    v_cvt_pk_bf16_f32 v152, v6, v7
    v_lshlrev_b32 v6, 16, v153
    v_and_b32 v7, 0xffff0000, v153
    v_mul_f32 v6, s29, v6
    v_mul_f32 v7, s29, v7
    v_cvt_pk_bf16_f32 v153, v6, v7
    v_lshlrev_b32 v6, 16, v154
    v_and_b32 v7, 0xffff0000, v154
    v_mul_f32 v6, s29, v6
    v_mul_f32 v7, s29, v7
    v_cvt_pk_bf16_f32 v154, v6, v7
    v_lshlrev_b32 v6, 16, v155
    v_and_b32 v7, 0xffff0000, v155
    v_mul_f32 v6, s29, v6
    v_mul_f32 v7, s29, v7
    v_cvt_pk_bf16_f32 v155, v6, v7
    v_lshlrev_b32 v6, 16, v156
    v_and_b32 v7, 0xffff0000, v156
    v_mul_f32 v6, s29, v6
    v_mul_f32 v7, s29, v7
    v_cvt_pk_bf16_f32 v156, v6, v7
    v_lshlrev_b32 v6, 16, v157
    v_and_b32 v7, 0xffff0000, v157
    v_mul_f32 v6, s29, v6
    v_mul_f32 v7, s29, v7
    v_cvt_pk_bf16_f32 v157, v6, v7
    v_lshlrev_b32 v6, 16, v158
    v_and_b32 v7, 0xffff0000, v158
    v_mul_f32 v6, s29, v6
    v_mul_f32 v7, s29, v7
    v_cvt_pk_bf16_f32 v158, v6, v7
    v_lshlrev_b32 v6, 16, v159
    v_and_b32 v7, 0xffff0000, v159
    v_mul_f32 v6, s29, v6
    v_mul_f32 v7, s29, v7
    v_cvt_pk_bf16_f32 v159, v6, v7
    s_waitcnt vmcnt(8)
    ds_read_b128 v[160:163], v8 offset:32768
    ds_read_b128 v[164:167], v9 offset:32768
    ds_read_b128 v[168:171], v10 offset:32768
    ds_read_b128 v[172:175], v11 offset:32768
    ds_read_b128 v[176:179], v12 offset:32768
    ds_read_b128 v[180:183], v13 offset:32768
    ds_read_b128 v[184:187], v14 offset:32768
    ds_read_b128 v[188:191], v15 offset:32768
    s_waitcnt lgkmcnt(0)
    s_add_u32 m0, s41, 32768
    s_add_u32 s30, s40, 24576
    s_xor_b32 s30, s30, s42
    buffer_load_dwordx4 v16, s[16:19], s30 offen offset:0 nt lds
    buffer_load_dwordx4 v17, s[16:19], s30 offen offset:1024 nt lds
    buffer_load_dwordx4 v18, s[16:19], s30 offen offset:2048 nt lds
    buffer_load_dwordx4 v19, s[16:19], s30 offen offset:3072 nt lds
    s_add_u32 m0, s41, 36864
    s_add_u32 s30, s40, 24576
    s_xor_b32 s30, s30, s42
    s_add_u32 s30, s30, 4096
    buffer_load_dwordx4 v16, s[16:19], s30 offen offset:0 nt lds
    buffer_load_dwordx4 v17, s[16:19], s30 offen offset:1024 nt lds
    buffer_load_dwordx4 v18, s[16:19], s30 offen offset:2048 nt lds
    buffer_load_dwordx4 v19, s[16:19], s30 offen offset:3072 nt lds
    s_setprio 1
    s_barrier
    ds_read_b128 v[32:35], v1 offset:0
    ds_read_b128 v[36:39], v1 offset:1056
    ds_read_b128 v[40:43], v1 offset:2112
    ds_read_b128 v[44:47], v1 offset:3168
    ds_read_b128 v[48:51], v1 offset:4224
    ds_read_b128 v[52:55], v1 offset:5280
    ds_read_b128 v[56:59], v1 offset:6336
    ds_read_b128 v[60:63], v1 offset:7392
    v_lshlrev_b32 v6, 16, v160
    v_and_b32 v7, 0xffff0000, v160
    v_mul_f32 v6, s29, v6
    v_mul_f32 v7, s29, v7
    v_cvt_pk_bf16_f32 v160, v6, v7
    v_lshlrev_b32 v6, 16, v161
    v_and_b32 v7, 0xffff0000, v161
    v_mul_f32 v6, s29, v6
    v_mul_f32 v7, s29, v7
    v_cvt_pk_bf16_f32 v161, v6, v7
    v_lshlrev_b32 v6, 16, v162
    v_and_b32 v7, 0xffff0000, v162
    v_mul_f32 v6, s29, v6
    v_mul_f32 v7, s29, v7
    v_cvt_pk_bf16_f32 v162, v6, v7
    v_lshlrev_b32 v6, 16, v163
    v_and_b32 v7, 0xffff0000, v163
    v_mul_f32 v6, s29, v6
    v_mul_f32 v7, s29, v7
    v_cvt_pk_bf16_f32 v163, v6, v7
    v_lshlrev_b32 v6, 16, v164
    v_and_b32 v7, 0xffff0000, v164
    v_mul_f32 v6, s29, v6
    v_mul_f32 v7, s29, v7
    v_cvt_pk_bf16_f32 v164, v6, v7
    v_lshlrev_b32 v6, 16, v165
    v_and_b32 v7, 0xffff0000, v165
    v_mul_f32 v6, s29, v6
    v_mul_f32 v7, s29, v7
    v_cvt_pk_bf16_f32 v165, v6, v7
    v_lshlrev_b32 v6, 16, v166
    v_and_b32 v7, 0xffff0000, v166
    v_mul_f32 v6, s29, v6
    v_mul_f32 v7, s29, v7
    v_cvt_pk_bf16_f32 v166, v6, v7
    v_lshlrev_b32 v6, 16, v167
    v_and_b32 v7, 0xffff0000, v167
    v_mul_f32 v6, s29, v6
    v_mul_f32 v7, s29, v7
    v_cvt_pk_bf16_f32 v167, v6, v7
    v_lshlrev_b32 v6, 16, v168
    v_and_b32 v7, 0xffff0000, v168
    v_mul_f32 v6, s29, v6
    v_mul_f32 v7, s29, v7
    v_cvt_pk_bf16_f32 v168, v6, v7
    v_lshlrev_b32 v6, 16, v169
    v_and_b32 v7, 0xffff0000, v169
    v_mul_f32 v6, s29, v6
    v_mul_f32 v7, s29, v7
    v_cvt_pk_bf16_f32 v169, v6, v7
    v_lshlrev_b32 v6, 16, v170
    v_and_b32 v7, 0xffff0000, v170
    v_mul_f32 v6, s29, v6
    v_mul_f32 v7, s29, v7
    v_cvt_pk_bf16_f32 v170, v6, v7
    v_lshlrev_b32 v6, 16, v171
    v_and_b32 v7, 0xffff0000, v171
    v_mul_f32 v6, s29, v6
    v_mul_f32 v7, s29, v7
    v_cvt_pk_bf16_f32 v171, v6, v7
    v_lshlrev_b32 v6, 16, v172
    v_and_b32 v7, 0xffff0000, v172
    v_mul_f32 v6, s29, v6
    v_mul_f32 v7, s29, v7
    v_cvt_pk_bf16_f32 v172, v6, v7
    v_lshlrev_b32 v6, 16, v173
    v_and_b32 v7, 0xffff0000, v173
    v_mul_f32 v6, s29, v6
    v_mul_f32 v7, s29, v7
    v_cvt_pk_bf16_f32 v173, v6, v7
    v_lshlrev_b32 v6, 16, v174
    v_and_b32 v7, 0xffff0000, v174
    v_mul_f32 v6, s29, v6
    v_mul_f32 v7, s29, v7
    v_cvt_pk_bf16_f32 v174, v6, v7
    v_lshlrev_b32 v6, 16, v175
    v_and_b32 v7, 0xffff0000, v175
    v_mul_f32 v6, s29, v6
    v_mul_f32 v7, s29, v7
    v_cvt_pk_bf16_f32 v175, v6, v7
    v_lshlrev_b32 v6, 16, v176
    v_and_b32 v7, 0xffff0000, v176
    v_mul_f32 v6, s29, v6
    v_mul_f32 v7, s29, v7
    v_cvt_pk_bf16_f32 v176, v6, v7
    v_lshlrev_b32 v6, 16, v177
    v_and_b32 v7, 0xffff0000, v177
    v_mul_f32 v6, s29, v6
    v_mul_f32 v7, s29, v7
    v_cvt_pk_bf16_f32 v177, v6, v7
    v_lshlrev_b32 v6, 16, v178
    v_and_b32 v7, 0xffff0000, v178
    v_mul_f32 v6, s29, v6
    v_mul_f32 v7, s29, v7
    v_cvt_pk_bf16_f32 v178, v6, v7
    v_lshlrev_b32 v6, 16, v179
    v_and_b32 v7, 0xffff0000, v179
    v_mul_f32 v6, s29, v6
    v_mul_f32 v7, s29, v7
    v_cvt_pk_bf16_f32 v179, v6, v7
    v_lshlrev_b32 v6, 16, v180
    v_and_b32 v7, 0xffff0000, v180
    v_mul_f32 v6, s29, v6
    v_mul_f32 v7, s29, v7
    v_cvt_pk_bf16_f32 v180, v6, v7
    v_lshlrev_b32 v6, 16, v181
    v_and_b32 v7, 0xffff0000, v181
    v_mul_f32 v6, s29, v6
    v_mul_f32 v7, s29, v7
    v_cvt_pk_bf16_f32 v181, v6, v7
    v_lshlrev_b32 v6, 16, v182
    v_and_b32 v7, 0xffff0000, v182
    v_mul_f32 v6, s29, v6
    v_mul_f32 v7, s29, v7
    v_cvt_pk_bf16_f32 v182, v6, v7
    v_lshlrev_b32 v6, 16, v183
    v_and_b32 v7, 0xffff0000, v183
    v_mul_f32 v6, s29, v6
    v_mul_f32 v7, s29, v7
    v_cvt_pk_bf16_f32 v183, v6, v7
    v_lshlrev_b32 v6, 16, v184
    v_and_b32 v7, 0xffff0000, v184
    v_mul_f32 v6, s29, v6
    v_mul_f32 v7, s29, v7
    v_cvt_pk_bf16_f32 v184, v6, v7
    v_lshlrev_b32 v6, 16, v185
    v_and_b32 v7, 0xffff0000, v185
    v_mul_f32 v6, s29, v6
    v_mul_f32 v7, s29, v7
    v_cvt_pk_bf16_f32 v185, v6, v7
    v_lshlrev_b32 v6, 16, v186
    v_and_b32 v7, 0xffff0000, v186
    v_mul_f32 v6, s29, v6
    v_mul_f32 v7, s29, v7
    v_cvt_pk_bf16_f32 v186, v6, v7
    v_lshlrev_b32 v6, 16, v187
    v_and_b32 v7, 0xffff0000, v187
    v_mul_f32 v6, s29, v6
    v_mul_f32 v7, s29, v7
    v_cvt_pk_bf16_f32 v187, v6, v7
    v_lshlrev_b32 v6, 16, v188
    v_and_b32 v7, 0xffff0000, v188
    v_mul_f32 v6, s29, v6
    v_mul_f32 v7, s29, v7
    v_cvt_pk_bf16_f32 v188, v6, v7
    v_lshlrev_b32 v6, 16, v189
    v_and_b32 v7, 0xffff0000, v189
    v_mul_f32 v6, s29, v6
    v_mul_f32 v7, s29, v7
    v_cvt_pk_bf16_f32 v189, v6, v7
    v_lshlrev_b32 v6, 16, v190
    v_and_b32 v7, 0xffff0000, v190
    v_mul_f32 v6, s29, v6
    v_mul_f32 v7, s29, v7
    v_cvt_pk_bf16_f32 v190, v6, v7
    v_lshlrev_b32 v6, 16, v191
    v_and_b32 v7, 0xffff0000, v191
    v_mul_f32 v6, s29, v6
    v_mul_f32 v7, s29, v7
    v_cvt_pk_bf16_f32 v191, v6, v7
    s_waitcnt lgkmcnt(7)
    v_mfma_f32_32x32x16_bf16 v[64:79], v[128:131], v[32:35], 0
    s_waitcnt lgkmcnt(6)
    v_mfma_f32_32x32x16_bf16 v[64:79], v[132:135], v[36:39], v[64:79]
    s_waitcnt lgkmcnt(5)
    v_mfma_f32_32x32x16_bf16 v[64:79], v[136:139], v[40:43], v[64:79]
    s_waitcnt lgkmcnt(4)
    v_mfma_f32_32x32x16_bf16 v[64:79], v[140:143], v[44:47], v[64:79]
    s_waitcnt lgkmcnt(3)
    v_mfma_f32_32x32x16_bf16 v[64:79], v[144:147], v[48:51], v[64:79]
    s_waitcnt lgkmcnt(2)
    v_mfma_f32_32x32x16_bf16 v[64:79], v[148:151], v[52:55], v[64:79]
    s_waitcnt lgkmcnt(1)
    v_mfma_f32_32x32x16_bf16 v[64:79], v[152:155], v[56:59], v[64:79]
    s_waitcnt lgkmcnt(0)
    v_mfma_f32_32x32x16_bf16 v[64:79], v[156:159], v[60:63], v[64:79]
    s_nop 7
    v_mfma_f32_32x32x16_bf16 v[80:95], v[160:163], v[32:35], 0
    s_nop 7
    v_mfma_f32_32x32x16_bf16 v[80:95], v[164:167], v[36:39], v[80:95]
    s_nop 7
    s_waitcnt vmcnt(8)
    ds_read_b128 v[192:195], v8 offset:0
    ds_read_b128 v[196:199], v9 offset:0
    ds_read_b128 v[200:203], v10 offset:0
    ds_read_b128 v[204:207], v11 offset:0
    ds_read_b128 v[208:211], v12 offset:0
    ds_read_b128 v[212:215], v13 offset:0
    ds_read_b128 v[216:219], v14 offset:0
    ds_read_b128 v[220:223], v15 offset:0
    v_mfma_f32_32x32x16_bf16 v[80:95], v[168:171], v[40:43], v[80:95]
    v_exp_f32 v64, v64
    v_exp_f32 v65, v65
    v_mov_b32 v4, v64
    v_mov_b32 v5, v65
    v_cvt_pk_bf16_f32 v16, v64, v65
    v_mfma_f32_32x32x16_bf16 v[80:95], v[172:175], v[44:47], v[80:95]
    v_exp_f32 v66, v66
    v_exp_f32 v67, v67
    v_add_f32 v4, v4, v66
    v_add_f32 v5, v5, v67
    v_cvt_pk_bf16_f32 v17, v66, v67
    s_waitcnt lgkmcnt(0)
    s_barrier
    v_mfma_f32_32x32x16_bf16 v[80:95], v[176:179], v[48:51], v[80:95]
    v_exp_f32 v68, v68
    v_exp_f32 v69, v69
    v_add_f32 v4, v4, v68
    v_add_f32 v5, v5, v69
    v_cvt_pk_bf16_f32 v18, v68, v69
    v_mfma_f32_32x32x16_bf16 v[80:95], v[180:183], v[52:55], v[80:95]
    v_exp_f32 v70, v70
    v_exp_f32 v71, v71
    v_add_f32 v4, v4, v70
    v_add_f32 v5, v5, v71
    v_cvt_pk_bf16_f32 v19, v70, v71
    ds_write_b128 v2, v[16:19] offset:0
    v_mfma_f32_32x32x16_bf16 v[80:95], v[184:187], v[56:59], v[80:95]
    v_exp_f32 v72, v72
    v_exp_f32 v73, v73
    v_add_f32 v4, v4, v72
    v_add_f32 v5, v5, v73
    v_cvt_pk_bf16_f32 v20, v72, v73
    v_mfma_f32_32x32x16_bf16 v[80:95], v[188:191], v[60:63], v[80:95]
    v_exp_f32 v74, v74
    v_exp_f32 v75, v75
    v_add_f32 v4, v4, v74
    v_add_f32 v5, v5, v75
    v_cvt_pk_bf16_f32 v21, v74, v75
    v_lshlrev_b32 v6, 16, v192
    v_and_b32 v7, 0xffff0000, v192
    v_mul_f32 v6, s29, v6
    v_mul_f32 v7, s29, v7
    v_cvt_pk_bf16_f32 v192, v6, v7
    v_lshlrev_b32 v6, 16, v193
    v_and_b32 v7, 0xffff0000, v193
    v_mul_f32 v6, s29, v6
    v_mul_f32 v7, s29, v7
    v_cvt_pk_bf16_f32 v193, v6, v7
    v_lshlrev_b32 v6, 16, v194
    v_and_b32 v7, 0xffff0000, v194
    v_mul_f32 v6, s29, v6
    v_mul_f32 v7, s29, v7
    v_cvt_pk_bf16_f32 v194, v6, v7
    v_lshlrev_b32 v6, 16, v195
    v_and_b32 v7, 0xffff0000, v195
    v_mul_f32 v6, s29, v6
    v_mul_f32 v7, s29, v7
    v_cvt_pk_bf16_f32 v195, v6, v7
    v_lshlrev_b32 v6, 16, v196
    v_and_b32 v7, 0xffff0000, v196
    v_mul_f32 v6, s29, v6
    v_mul_f32 v7, s29, v7
    v_cvt_pk_bf16_f32 v196, v6, v7
    v_lshlrev_b32 v6, 16, v197
    v_and_b32 v7, 0xffff0000, v197
    v_mul_f32 v6, s29, v6
    v_mul_f32 v7, s29, v7
    v_cvt_pk_bf16_f32 v197, v6, v7
    v_lshlrev_b32 v6, 16, v198
    v_and_b32 v7, 0xffff0000, v198
    v_mul_f32 v6, s29, v6
    v_mul_f32 v7, s29, v7
    v_cvt_pk_bf16_f32 v198, v6, v7
    v_lshlrev_b32 v6, 16, v199
    v_and_b32 v7, 0xffff0000, v199
    v_mul_f32 v6, s29, v6
    v_mul_f32 v7, s29, v7
    v_cvt_pk_bf16_f32 v199, v6, v7
    v_lshlrev_b32 v6, 16, v200
    v_and_b32 v7, 0xffff0000, v200
    v_mul_f32 v6, s29, v6
    v_mul_f32 v7, s29, v7
    v_cvt_pk_bf16_f32 v200, v6, v7
    v_lshlrev_b32 v6, 16, v201
    v_and_b32 v7, 0xffff0000, v201
    v_mul_f32 v6, s29, v6
    v_mul_f32 v7, s29, v7
    v_cvt_pk_bf16_f32 v201, v6, v7
    v_lshlrev_b32 v6, 16, v202
    v_and_b32 v7, 0xffff0000, v202
    v_mul_f32 v6, s29, v6
    v_mul_f32 v7, s29, v7
    v_cvt_pk_bf16_f32 v202, v6, v7
    v_lshlrev_b32 v6, 16, v203
    v_and_b32 v7, 0xffff0000, v203
    v_mul_f32 v6, s29, v6
    v_mul_f32 v7, s29, v7
    v_cvt_pk_bf16_f32 v203, v6, v7
    v_lshlrev_b32 v6, 16, v204
    v_and_b32 v7, 0xffff0000, v204
    v_mul_f32 v6, s29, v6
    v_mul_f32 v7, s29, v7
    v_cvt_pk_bf16_f32 v204, v6, v7
    v_lshlrev_b32 v6, 16, v205
    v_and_b32 v7, 0xffff0000, v205
    v_mul_f32 v6, s29, v6
    v_mul_f32 v7, s29, v7
    v_cvt_pk_bf16_f32 v205, v6, v7
    v_lshlrev_b32 v6, 16, v206
    v_and_b32 v7, 0xffff0000, v206
    v_mul_f32 v6, s29, v6
    v_mul_f32 v7, s29, v7
    v_cvt_pk_bf16_f32 v206, v6, v7
    v_lshlrev_b32 v6, 16, v207
    v_and_b32 v7, 0xffff0000, v207
    v_mul_f32 v6, s29, v6
    v_mul_f32 v7, s29, v7
    v_cvt_pk_bf16_f32 v207, v6, v7
    v_lshlrev_b32 v6, 16, v208
    v_and_b32 v7, 0xffff0000, v208
    v_mul_f32 v6, s29, v6
    v_mul_f32 v7, s29, v7
    v_cvt_pk_bf16_f32 v208, v6, v7
    v_lshlrev_b32 v6, 16, v209
    v_and_b32 v7, 0xffff0000, v209
    v_mul_f32 v6, s29, v6
    v_mul_f32 v7, s29, v7
    v_cvt_pk_bf16_f32 v209, v6, v7
    v_lshlrev_b32 v6, 16, v210
    v_and_b32 v7, 0xffff0000, v210
    v_mul_f32 v6, s29, v6
    v_mul_f32 v7, s29, v7
    v_cvt_pk_bf16_f32 v210, v6, v7
    v_lshlrev_b32 v6, 16, v211
    v_and_b32 v7, 0xffff0000, v211
    v_mul_f32 v6, s29, v6
    v_mul_f32 v7, s29, v7
    v_cvt_pk_bf16_f32 v211, v6, v7
    v_lshlrev_b32 v6, 16, v212
    v_and_b32 v7, 0xffff0000, v212
    v_mul_f32 v6, s29, v6
    v_mul_f32 v7, s29, v7
    v_cvt_pk_bf16_f32 v212, v6, v7
    v_lshlrev_b32 v6, 16, v213
    v_and_b32 v7, 0xffff0000, v213
    v_mul_f32 v6, s29, v6
    v_mul_f32 v7, s29, v7
    v_cvt_pk_bf16_f32 v213, v6, v7
    v_lshlrev_b32 v6, 16, v214
    v_and_b32 v7, 0xffff0000, v214
    v_mul_f32 v6, s29, v6
    v_mul_f32 v7, s29, v7
    v_cvt_pk_bf16_f32 v214, v6, v7
    v_lshlrev_b32 v6, 16, v215
    v_and_b32 v7, 0xffff0000, v215
    v_mul_f32 v6, s29, v6
    v_mul_f32 v7, s29, v7
    v_cvt_pk_bf16_f32 v215, v6, v7
    v_lshlrev_b32 v6, 16, v216
    v_and_b32 v7, 0xffff0000, v216
    v_mul_f32 v6, s29, v6
    v_mul_f32 v7, s29, v7
    v_cvt_pk_bf16_f32 v216, v6, v7
    v_lshlrev_b32 v6, 16, v217
    v_and_b32 v7, 0xffff0000, v217
    v_mul_f32 v6, s29, v6
    v_mul_f32 v7, s29, v7
    v_cvt_pk_bf16_f32 v217, v6, v7
    v_lshlrev_b32 v6, 16, v218
    v_and_b32 v7, 0xffff0000, v218
    v_mul_f32 v6, s29, v6
    v_mul_f32 v7, s29, v7
    v_cvt_pk_bf16_f32 v218, v6, v7
    v_lshlrev_b32 v6, 16, v219
    v_and_b32 v7, 0xffff0000, v219
    v_mul_f32 v6, s29, v6
    v_mul_f32 v7, s29, v7
    v_cvt_pk_bf16_f32 v219, v6, v7
    v_lshlrev_b32 v6, 16, v220
    v_and_b32 v7, 0xffff0000, v220
    v_mul_f32 v6, s29, v6
    v_mul_f32 v7, s29, v7
    v_cvt_pk_bf16_f32 v220, v6, v7
    v_lshlrev_b32 v6, 16, v221
    v_and_b32 v7, 0xffff0000, v221
    v_mul_f32 v6, s29, v6
    v_mul_f32 v7, s29, v7
    v_cvt_pk_bf16_f32 v221, v6, v7
    v_lshlrev_b32 v6, 16, v222
    v_and_b32 v7, 0xffff0000, v222
    v_mul_f32 v6, s29, v6
    v_mul_f32 v7, s29, v7
    v_cvt_pk_bf16_f32 v222, v6, v7
    v_lshlrev_b32 v6, 16, v223
    v_and_b32 v7, 0xffff0000, v223
    v_mul_f32 v6, s29, v6
    v_mul_f32 v7, s29, v7
    v_cvt_pk_bf16_f32 v223, v6, v7
    s_waitcnt vmcnt(0)
    ds_read_b128 v[224:227], v8 offset:32768
    ds_read_b128 v[228:231], v9 offset:32768
    ds_read_b128 v[232:235], v10 offset:32768
    ds_read_b128 v[236:239], v11 offset:32768
    ds_read_b128 v[240:243], v12 offset:32768
    ds_read_b128 v[244:247], v13 offset:32768
    ds_read_b128 v[248:251], v14 offset:32768
    ds_read_b128 v[252:255], v15 offset:32768
    v_mfma_f32_32x32x16_bf16 v[96:111], v[192:195], v[32:35], 0
    v_exp_f32 v76, v76
    v_exp_f32 v77, v77
    v_add_f32 v4, v4, v76
    v_add_f32 v5, v5, v77
    v_cvt_pk_bf16_f32 v22, v76, v77
    v_mfma_f32_32x32x16_bf16 v[96:111], v[196:199], v[36:39], v[96:111]
    v_exp_f32 v78, v78
    v_exp_f32 v79, v79
    v_add_f32 v4, v4, v78
    v_add_f32 v5, v5, v79
    v_cvt_pk_bf16_f32 v23, v78, v79
    ds_write_b128 v2, v[20:23] offset:1024
    v_mfma_f32_32x32x16_bf16 v[96:111], v[200:203], v[40:43], v[96:111]
    v_exp_f32 v80, v80
    v_exp_f32 v81, v81
    v_add_f32 v4, v4, v80
    v_add_f32 v5, v5, v81
    v_cvt_pk_bf16_f32 v24, v80, v81
    v_mfma_f32_32x32x16_bf16 v[96:111], v[204:207], v[44:47], v[96:111]
    v_exp_f32 v82, v82
    v_exp_f32 v83, v83
    v_add_f32 v4, v4, v82
    v_add_f32 v5, v5, v83
    v_cvt_pk_bf16_f32 v25, v82, v83
    v_mfma_f32_32x32x16_bf16 v[96:111], v[208:211], v[48:51], v[96:111]
    v_exp_f32 v84, v84
    v_exp_f32 v85, v85
    v_add_f32 v4, v4, v84
    v_add_f32 v5, v5, v85
    v_cvt_pk_bf16_f32 v26, v84, v85
    v_mfma_f32_32x32x16_bf16 v[96:111], v[212:215], v[52:55], v[96:111]
    v_exp_f32 v86, v86
    v_exp_f32 v87, v87
    v_add_f32 v4, v4, v86
    v_add_f32 v5, v5, v87
    v_cvt_pk_bf16_f32 v27, v86, v87
    ds_write_b128 v2, v[24:27] offset:2048
    v_mfma_f32_32x32x16_bf16 v[96:111], v[216:219], v[56:59], v[96:111]
    v_exp_f32 v88, v88
    v_exp_f32 v89, v89
    v_add_f32 v4, v4, v88
    v_add_f32 v5, v5, v89
    v_cvt_pk_bf16_f32 v28, v88, v89
    v_mfma_f32_32x32x16_bf16 v[96:111], v[220:223], v[60:63], v[96:111]
    v_exp_f32 v90, v90
    v_exp_f32 v91, v91
    v_add_f32 v4, v4, v90
    v_add_f32 v5, v5, v91
    v_cvt_pk_bf16_f32 v29, v90, v91
    s_waitcnt lgkmcnt(2)
    v_lshlrev_b32 v6, 16, v224
    v_and_b32 v7, 0xffff0000, v224
    v_mul_f32 v6, s29, v6
    v_mul_f32 v7, s29, v7
    v_cvt_pk_bf16_f32 v224, v6, v7
    v_lshlrev_b32 v6, 16, v225
    v_and_b32 v7, 0xffff0000, v225
    v_mul_f32 v6, s29, v6
    v_mul_f32 v7, s29, v7
    v_cvt_pk_bf16_f32 v225, v6, v7
    v_lshlrev_b32 v6, 16, v226
    v_and_b32 v7, 0xffff0000, v226
    v_mul_f32 v6, s29, v6
    v_mul_f32 v7, s29, v7
    v_cvt_pk_bf16_f32 v226, v6, v7
    v_lshlrev_b32 v6, 16, v227
    v_and_b32 v7, 0xffff0000, v227
    v_mul_f32 v6, s29, v6
    v_mul_f32 v7, s29, v7
    v_cvt_pk_bf16_f32 v227, v6, v7
    v_lshlrev_b32 v6, 16, v228
    v_and_b32 v7, 0xffff0000, v228
    v_mul_f32 v6, s29, v6
    v_mul_f32 v7, s29, v7
    v_cvt_pk_bf16_f32 v228, v6, v7
    v_lshlrev_b32 v6, 16, v229
    v_and_b32 v7, 0xffff0000, v229
    v_mul_f32 v6, s29, v6
    v_mul_f32 v7, s29, v7
    v_cvt_pk_bf16_f32 v229, v6, v7
    v_lshlrev_b32 v6, 16, v230
    v_and_b32 v7, 0xffff0000, v230
    v_mul_f32 v6, s29, v6
    v_mul_f32 v7, s29, v7
    v_cvt_pk_bf16_f32 v230, v6, v7
    v_lshlrev_b32 v6, 16, v231
    v_and_b32 v7, 0xffff0000, v231
    v_mul_f32 v6, s29, v6
    v_mul_f32 v7, s29, v7
    v_cvt_pk_bf16_f32 v231, v6, v7
    v_lshlrev_b32 v6, 16, v232
    v_and_b32 v7, 0xffff0000, v232
    v_mul_f32 v6, s29, v6
    v_mul_f32 v7, s29, v7
    v_cvt_pk_bf16_f32 v232, v6, v7
    v_lshlrev_b32 v6, 16, v233
    v_and_b32 v7, 0xffff0000, v233
    v_mul_f32 v6, s29, v6
    v_mul_f32 v7, s29, v7
    v_cvt_pk_bf16_f32 v233, v6, v7
    v_lshlrev_b32 v6, 16, v234
    v_and_b32 v7, 0xffff0000, v234
    v_mul_f32 v6, s29, v6
    v_mul_f32 v7, s29, v7
    v_cvt_pk_bf16_f32 v234, v6, v7
    v_lshlrev_b32 v6, 16, v235
    v_and_b32 v7, 0xffff0000, v235
    v_mul_f32 v6, s29, v6
    v_mul_f32 v7, s29, v7
    v_cvt_pk_bf16_f32 v235, v6, v7
    v_lshlrev_b32 v6, 16, v236
    v_and_b32 v7, 0xffff0000, v236
    v_mul_f32 v6, s29, v6
    v_mul_f32 v7, s29, v7
    v_cvt_pk_bf16_f32 v236, v6, v7
    v_lshlrev_b32 v6, 16, v237
    v_and_b32 v7, 0xffff0000, v237
    v_mul_f32 v6, s29, v6
    v_mul_f32 v7, s29, v7
    v_cvt_pk_bf16_f32 v237, v6, v7
    v_lshlrev_b32 v6, 16, v238
    v_and_b32 v7, 0xffff0000, v238
    v_mul_f32 v6, s29, v6
    v_mul_f32 v7, s29, v7
    v_cvt_pk_bf16_f32 v238, v6, v7
    v_lshlrev_b32 v6, 16, v239
    v_and_b32 v7, 0xffff0000, v239
    v_mul_f32 v6, s29, v6
    v_mul_f32 v7, s29, v7
    v_cvt_pk_bf16_f32 v239, v6, v7
    v_lshlrev_b32 v6, 16, v240
    v_and_b32 v7, 0xffff0000, v240
    v_mul_f32 v6, s29, v6
    v_mul_f32 v7, s29, v7
    v_cvt_pk_bf16_f32 v240, v6, v7
    v_lshlrev_b32 v6, 16, v241
    v_and_b32 v7, 0xffff0000, v241
    v_mul_f32 v6, s29, v6
    v_mul_f32 v7, s29, v7
    v_cvt_pk_bf16_f32 v241, v6, v7
    v_lshlrev_b32 v6, 16, v242
    v_and_b32 v7, 0xffff0000, v242
    v_mul_f32 v6, s29, v6
    v_mul_f32 v7, s29, v7
    v_cvt_pk_bf16_f32 v242, v6, v7
    v_lshlrev_b32 v6, 16, v243
    v_and_b32 v7, 0xffff0000, v243
    v_mul_f32 v6, s29, v6
    v_mul_f32 v7, s29, v7
    v_cvt_pk_bf16_f32 v243, v6, v7
    v_lshlrev_b32 v6, 16, v244
    v_and_b32 v7, 0xffff0000, v244
    v_mul_f32 v6, s29, v6
    v_mul_f32 v7, s29, v7
    v_cvt_pk_bf16_f32 v244, v6, v7
    v_lshlrev_b32 v6, 16, v245
    v_and_b32 v7, 0xffff0000, v245
    v_mul_f32 v6, s29, v6
    v_mul_f32 v7, s29, v7
    v_cvt_pk_bf16_f32 v245, v6, v7
    v_lshlrev_b32 v6, 16, v246
    v_and_b32 v7, 0xffff0000, v246
    v_mul_f32 v6, s29, v6
    v_mul_f32 v7, s29, v7
    v_cvt_pk_bf16_f32 v246, v6, v7
    v_lshlrev_b32 v6, 16, v247
    v_and_b32 v7, 0xffff0000, v247
    v_mul_f32 v6, s29, v6
    v_mul_f32 v7, s29, v7
    v_cvt_pk_bf16_f32 v247, v6, v7
    v_lshlrev_b32 v6, 16, v248
    v_and_b32 v7, 0xffff0000, v248
    v_mul_f32 v6, s29, v6
    v_mul_f32 v7, s29, v7
    v_cvt_pk_bf16_f32 v248, v6, v7
    v_lshlrev_b32 v6, 16, v249
    v_and_b32 v7, 0xffff0000, v249
    v_mul_f32 v6, s29, v6
    v_mul_f32 v7, s29, v7
    v_cvt_pk_bf16_f32 v249, v6, v7
    v_lshlrev_b32 v6, 16, v250
    v_and_b32 v7, 0xffff0000, v250
    v_mul_f32 v6, s29, v6
    v_mul_f32 v7, s29, v7
    v_cvt_pk_bf16_f32 v250, v6, v7
    v_lshlrev_b32 v6, 16, v251
    v_and_b32 v7, 0xffff0000, v251
    v_mul_f32 v6, s29, v6
    v_mul_f32 v7, s29, v7
    v_cvt_pk_bf16_f32 v251, v6, v7
    v_lshlrev_b32 v6, 16, v252
    v_and_b32 v7, 0xffff0000, v252
    v_mul_f32 v6, s29, v6
    v_mul_f32 v7, s29, v7
    v_cvt_pk_bf16_f32 v252, v6, v7
    v_lshlrev_b32 v6, 16, v253
    v_and_b32 v7, 0xffff0000, v253
    v_mul_f32 v6, s29, v6
    v_mul_f32 v7, s29, v7
    v_cvt_pk_bf16_f32 v253, v6, v7
    v_lshlrev_b32 v6, 16, v254
    v_and_b32 v7, 0xffff0000, v254
    v_mul_f32 v6, s29, v6
    v_mul_f32 v7, s29, v7
    v_cvt_pk_bf16_f32 v254, v6, v7
    v_lshlrev_b32 v6, 16, v255
    v_and_b32 v7, 0xffff0000, v255
    v_mul_f32 v6, s29, v6
    v_mul_f32 v7, s29, v7
    v_cvt_pk_bf16_f32 v255, v6, v7
    v_mfma_f32_32x32x16_bf16 v[112:127], v[224:227], v[32:35], 0
    ds_read_b128 v[32:35], v1 offset:8448
    v_exp_f32 v92, v92
    v_exp_f32 v93, v93
    v_add_f32 v4, v4, v92
    v_add_f32 v5, v5, v93
    v_cvt_pk_bf16_f32 v30, v92, v93
    v_mfma_f32_32x32x16_bf16 v[112:127], v[228:231], v[36:39], v[112:127]
    ds_read_b128 v[36:39], v1 offset:9504
    v_exp_f32 v94, v94
    v_exp_f32 v95, v95
    v_add_f32 v4, v4, v94
    v_add_f32 v5, v5, v95
    v_cvt_pk_bf16_f32 v31, v94, v95
    ds_write_b128 v2, v[28:31] offset:3072
    v_mfma_f32_32x32x16_bf16 v[112:127], v[232:235], v[40:43], v[112:127]
    ds_read_b128 v[40:43], v1 offset:10560
    v_exp_f32 v96, v96
    v_exp_f32 v97, v97
    v_add_f32 v4, v4, v96
    v_add_f32 v5, v5, v97
    v_cvt_pk_bf16_f32 v16, v96, v97
    v_mfma_f32_32x32x16_bf16 v[112:127], v[236:239], v[44:47], v[112:127]
    ds_read_b128 v[44:47], v1 offset:11616
    v_exp_f32 v98, v98
    v_exp_f32 v99, v99
    v_add_f32 v4, v4, v98
    v_add_f32 v5, v5, v99
    v_cvt_pk_bf16_f32 v17, v98, v99
    v_mfma_f32_32x32x16_bf16 v[112:127], v[240:243], v[48:51], v[112:127]
    ds_read_b128 v[48:51], v1 offset:12672
    v_exp_f32 v100, v100
    v_exp_f32 v101, v101
    v_add_f32 v4, v4, v100
    v_add_f32 v5, v5, v101
    v_cvt_pk_bf16_f32 v18, v100, v101
    v_mfma_f32_32x32x16_bf16 v[112:127], v[244:247], v[52:55], v[112:127]
    ds_read_b128 v[52:55], v1 offset:13728
    v_exp_f32 v102, v102
    v_exp_f32 v103, v103
    v_add_f32 v4, v4, v102
    v_add_f32 v5, v5, v103
    v_cvt_pk_bf16_f32 v19, v102, v103
    ds_write_b128 v2, v[16:19] offset:4096
    v_mfma_f32_32x32x16_bf16 v[112:127], v[248:251], v[56:59], v[112:127]
    ds_read_b128 v[56:59], v1 offset:14784
    v_exp_f32 v104, v104
    v_exp_f32 v105, v105
    v_add_f32 v4, v4, v104
    v_add_f32 v5, v5, v105
    v_cvt_pk_bf16_f32 v20, v104, v105
    v_mfma_f32_32x32x16_bf16 v[112:127], v[252:255], v[60:63], v[112:127]
    ds_read_b128 v[60:63], v1 offset:15840
    v_exp_f32 v106, v106
    v_exp_f32 v107, v107
    v_add_f32 v4, v4, v106
    v_add_f32 v5, v5, v107
    v_cvt_pk_bf16_f32 v21, v106, v107
    s_mov_b32 s26, 8
L_qk_loop:
    s_waitcnt lgkmcnt(9)
    v_mfma_f32_32x32x16_bf16 v[64:79], v[128:131], v[32:35], 0
    v_exp_f32 v108, v108
    v_exp_f32 v109, v109
    v_add_f32 v4, v4, v108
    v_add_f32 v5, v5, v109
    v_cvt_pk_bf16_f32 v22, v108, v109
    s_waitcnt lgkmcnt(8)
    v_mfma_f32_32x32x16_bf16 v[64:79], v[132:135], v[36:39], v[64:79]
    v_exp_f32 v110, v110
    v_exp_f32 v111, v111
    v_add_f32 v4, v4, v110
    v_add_f32 v5, v5, v111
    v_cvt_pk_bf16_f32 v23, v110, v111
    ds_write_b128 v2, v[20:23] offset:5120
    s_waitcnt lgkmcnt(7)
    v_mfma_f32_32x32x16_bf16 v[64:79], v[136:139], v[40:43], v[64:79]
    v_exp_f32 v112, v112
    v_exp_f32 v113, v113
    v_add_f32 v4, v4, v112
    v_add_f32 v5, v5, v113
    v_cvt_pk_bf16_f32 v24, v112, v113
    s_waitcnt lgkmcnt(6)
    v_mfma_f32_32x32x16_bf16 v[64:79], v[140:143], v[44:47], v[64:79]
    v_exp_f32 v114, v114
    v_exp_f32 v115, v115
    v_add_f32 v4, v4, v114
    v_add_f32 v5, v5, v115
    v_cvt_pk_bf16_f32 v25, v114, v115
    s_waitcnt lgkmcnt(5)
    v_mfma_f32_32x32x16_bf16 v[64:79], v[144:147], v[48:51], v[64:79]
    v_exp_f32 v116, v116
    v_exp_f32 v117, v117
    v_add_f32 v4, v4, v116
    v_add_f32 v5, v5, v117
    v_cvt_pk_bf16_f32 v26, v116, v117
    s_waitcnt lgkmcnt(4)
    v_mfma_f32_32x32x16_bf16 v[64:79], v[148:151], v[52:55], v[64:79]
    v_exp_f32 v118, v118
    v_exp_f32 v119, v119
    v_add_f32 v4, v4, v118
    v_add_f32 v5, v5, v119
    v_cvt_pk_bf16_f32 v27, v118, v119
    ds_write_b128 v2, v[24:27] offset:6144
    s_waitcnt lgkmcnt(3)
    v_mfma_f32_32x32x16_bf16 v[64:79], v[152:155], v[56:59], v[64:79]
    v_exp_f32 v120, v120
    v_exp_f32 v121, v121
    v_add_f32 v4, v4, v120
    v_add_f32 v5, v5, v121
    v_cvt_pk_bf16_f32 v28, v120, v121
    s_waitcnt lgkmcnt(2)
    v_mfma_f32_32x32x16_bf16 v[64:79], v[156:159], v[60:63], v[64:79]
    v_exp_f32 v122, v122
    v_exp_f32 v123, v123
    v_add_f32 v4, v4, v122
    v_add_f32 v5, v5, v123
    v_cvt_pk_bf16_f32 v29, v122, v123
    v_mfma_f32_32x32x16_bf16 v[80:95], v[160:163], v[32:35], 0
    v_exp_f32 v124, v124
    v_exp_f32 v125, v125
    v_add_f32 v4, v4, v124
    v_add_f32 v5, v5, v125
    v_cvt_pk_bf16_f32 v30, v124, v125
    v_mfma_f32_32x32x16_bf16 v[80:95], v[164:167], v[36:39], v[80:95]
    v_exp_f32 v126, v126
    v_exp_f32 v127, v127
    v_add_f32 v4, v4, v126
    v_add_f32 v5, v5, v127
    v_cvt_pk_bf16_f32 v31, v126, v127
    ds_write_b128 v2, v[28:31] offset:7168
    v_add_f32 v6, v4, v5
    ds_write_b32 v3, v6 offset:0
    v_mfma_f32_32x32x16_bf16 v[80:95], v[168:171], v[40:43], v[80:95]
    v_exp_f32 v64, v64
    v_exp_f32 v65, v65
    v_mov_b32 v4, v64
    v_mov_b32 v5, v65
    v_cvt_pk_bf16_f32 v16, v64, v65
    v_mfma_f32_32x32x16_bf16 v[80:95], v[172:175], v[44:47], v[80:95]
    v_exp_f32 v66, v66
    v_exp_f32 v67, v67
    v_add_f32 v4, v4, v66
    v_add_f32 v5, v5, v67
    v_cvt_pk_bf16_f32 v17, v66, v67
    s_waitcnt lgkmcnt(0)
    s_barrier
    v_mfma_f32_32x32x16_bf16 v[80:95], v[176:179], v[48:51], v[80:95]
    v_exp_f32 v68, v68
    v_exp_f32 v69, v69
    v_add_f32 v4, v4, v68
    v_add_f32 v5, v5, v69
    v_cvt_pk_bf16_f32 v18, v68, v69
    v_mfma_f32_32x32x16_bf16 v[80:95], v[180:183], v[52:55], v[80:95]
    v_exp_f32 v70, v70
    v_exp_f32 v71, v71
    v_add_f32 v4, v4, v70
    v_add_f32 v5, v5, v71
    v_cvt_pk_bf16_f32 v19, v70, v71
    ds_write_b128 v2, v[16:19] offset:32768
    v_mfma_f32_32x32x16_bf16 v[80:95], v[184:187], v[56:59], v[80:95]
    v_exp_f32 v72, v72
    v_exp_f32 v73, v73
    v_add_f32 v4, v4, v72
    v_add_f32 v5, v5, v73
    v_cvt_pk_bf16_f32 v20, v72, v73
    v_mfma_f32_32x32x16_bf16 v[80:95], v[188:191], v[60:63], v[80:95]
    v_exp_f32 v74, v74
    v_exp_f32 v75, v75
    v_add_f32 v4, v4, v74
    v_add_f32 v5, v5, v75
    v_cvt_pk_bf16_f32 v21, v74, v75
    v_mfma_f32_32x32x16_bf16 v[96:111], v[192:195], v[32:35], 0
    v_exp_f32 v76, v76
    v_exp_f32 v77, v77
    v_add_f32 v4, v4, v76
    v_add_f32 v5, v5, v77
    v_cvt_pk_bf16_f32 v22, v76, v77
    v_mfma_f32_32x32x16_bf16 v[96:111], v[196:199], v[36:39], v[96:111]
    v_exp_f32 v78, v78
    v_exp_f32 v79, v79
    v_add_f32 v4, v4, v78
    v_add_f32 v5, v5, v79
    v_cvt_pk_bf16_f32 v23, v78, v79
    ds_write_b128 v2, v[20:23] offset:33792
    v_mfma_f32_32x32x16_bf16 v[96:111], v[200:203], v[40:43], v[96:111]
    v_exp_f32 v80, v80
    v_exp_f32 v81, v81
    v_add_f32 v4, v4, v80
    v_add_f32 v5, v5, v81
    v_cvt_pk_bf16_f32 v24, v80, v81
    v_mfma_f32_32x32x16_bf16 v[96:111], v[204:207], v[44:47], v[96:111]
    v_exp_f32 v82, v82
    v_exp_f32 v83, v83
    v_add_f32 v4, v4, v82
    v_add_f32 v5, v5, v83
    v_cvt_pk_bf16_f32 v25, v82, v83
    v_mfma_f32_32x32x16_bf16 v[96:111], v[208:211], v[48:51], v[96:111]
    v_exp_f32 v84, v84
    v_exp_f32 v85, v85
    v_add_f32 v4, v4, v84
    v_add_f32 v5, v5, v85
    v_cvt_pk_bf16_f32 v26, v84, v85
    v_mfma_f32_32x32x16_bf16 v[96:111], v[212:215], v[52:55], v[96:111]
    v_exp_f32 v86, v86
    v_exp_f32 v87, v87
    v_add_f32 v4, v4, v86
    v_add_f32 v5, v5, v87
    v_cvt_pk_bf16_f32 v27, v86, v87
    ds_write_b128 v2, v[24:27] offset:34816
    v_mfma_f32_32x32x16_bf16 v[96:111], v[216:219], v[56:59], v[96:111]
    v_exp_f32 v88, v88
    v_exp_f32 v89, v89
    v_add_f32 v4, v4, v88
    v_add_f32 v5, v5, v89
    v_cvt_pk_bf16_f32 v28, v88, v89
    v_mfma_f32_32x32x16_bf16 v[96:111], v[220:223], v[60:63], v[96:111]
    v_exp_f32 v90, v90
    v_exp_f32 v91, v91
    v_add_f32 v4, v4, v90
    v_add_f32 v5, v5, v91
    v_cvt_pk_bf16_f32 v29, v90, v91
    v_mfma_f32_32x32x16_bf16 v[112:127], v[224:227], v[32:35], 0
    ds_read_b128 v[32:35], v1 offset:0
    v_exp_f32 v92, v92
    v_exp_f32 v93, v93
    v_add_f32 v4, v4, v92
    v_add_f32 v5, v5, v93
    v_cvt_pk_bf16_f32 v30, v92, v93
    v_mfma_f32_32x32x16_bf16 v[112:127], v[228:231], v[36:39], v[112:127]
    ds_read_b128 v[36:39], v1 offset:1056
    v_exp_f32 v94, v94
    v_exp_f32 v95, v95
    v_add_f32 v4, v4, v94
    v_add_f32 v5, v5, v95
    v_cvt_pk_bf16_f32 v31, v94, v95
    ds_write_b128 v2, v[28:31] offset:35840
    v_mfma_f32_32x32x16_bf16 v[112:127], v[232:235], v[40:43], v[112:127]
    ds_read_b128 v[40:43], v1 offset:2112
    v_exp_f32 v96, v96
    v_exp_f32 v97, v97
    v_add_f32 v4, v4, v96
    v_add_f32 v5, v5, v97
    v_cvt_pk_bf16_f32 v16, v96, v97
    v_mfma_f32_32x32x16_bf16 v[112:127], v[236:239], v[44:47], v[112:127]
    ds_read_b128 v[44:47], v1 offset:3168
    v_exp_f32 v98, v98
    v_exp_f32 v99, v99
    v_add_f32 v4, v4, v98
    v_add_f32 v5, v5, v99
    v_cvt_pk_bf16_f32 v17, v98, v99
    v_mfma_f32_32x32x16_bf16 v[112:127], v[240:243], v[48:51], v[112:127]
    ds_read_b128 v[48:51], v1 offset:4224
    v_exp_f32 v100, v100
    v_exp_f32 v101, v101
    v_add_f32 v4, v4, v100
    v_add_f32 v5, v5, v101
    v_cvt_pk_bf16_f32 v18, v100, v101
    v_mfma_f32_32x32x16_bf16 v[112:127], v[244:247], v[52:55], v[112:127]
    ds_read_b128 v[52:55], v1 offset:5280
    v_exp_f32 v102, v102
    v_exp_f32 v103, v103
    v_add_f32 v4, v4, v102
    v_add_f32 v5, v5, v103
    v_cvt_pk_bf16_f32 v19, v102, v103
    ds_write_b128 v2, v[16:19] offset:36864
    v_mfma_f32_32x32x16_bf16 v[112:127], v[248:251], v[56:59], v[112:127]
    ds_read_b128 v[56:59], v1 offset:6336
    v_exp_f32 v104, v104
    v_exp_f32 v105, v105
    v_add_f32 v4, v4, v104
    v_add_f32 v5, v5, v105
    v_cvt_pk_bf16_f32 v20, v104, v105
    v_mfma_f32_32x32x16_bf16 v[112:127], v[252:255], v[60:63], v[112:127]
    ds_read_b128 v[60:63], v1 offset:7392
    v_exp_f32 v106, v106
    v_exp_f32 v107, v107
    v_add_f32 v4, v4, v106
    v_add_f32 v5, v5, v107
    v_cvt_pk_bf16_f32 v21, v106, v107
    s_waitcnt lgkmcnt(9)
    v_mfma_f32_32x32x16_bf16 v[64:79], v[128:131], v[32:35], 0
    v_exp_f32 v108, v108
    v_exp_f32 v109, v109
    v_add_f32 v4, v4, v108
    v_add_f32 v5, v5, v109
    v_cvt_pk_bf16_f32 v22, v108, v109
    s_waitcnt lgkmcnt(8)
    v_mfma_f32_32x32x16_bf16 v[64:79], v[132:135], v[36:39], v[64:79]
    v_exp_f32 v110, v110
    v_exp_f32 v111, v111
    v_add_f32 v4, v4, v110
    v_add_f32 v5, v5, v111
    v_cvt_pk_bf16_f32 v23, v110, v111
    ds_write_b128 v2, v[20:23] offset:37888
    s_waitcnt lgkmcnt(7)
    v_mfma_f32_32x32x16_bf16 v[64:79], v[136:139], v[40:43], v[64:79]
    v_exp_f32 v112, v112
    v_exp_f32 v113, v113
    v_add_f32 v4, v4, v112
    v_add_f32 v5, v5, v113
    v_cvt_pk_bf16_f32 v24, v112, v113
    s_waitcnt lgkmcnt(6)
    v_mfma_f32_32x32x16_bf16 v[64:79], v[140:143], v[44:47], v[64:79]
    v_exp_f32 v114, v114
    v_exp_f32 v115, v115
    v_add_f32 v4, v4, v114
    v_add_f32 v5, v5, v115
    v_cvt_pk_bf16_f32 v25, v114, v115
    s_waitcnt lgkmcnt(5)
    v_mfma_f32_32x32x16_bf16 v[64:79], v[144:147], v[48:51], v[64:79]
    v_exp_f32 v116, v116
    v_exp_f32 v117, v117
    v_add_f32 v4, v4, v116
    v_add_f32 v5, v5, v117
    v_cvt_pk_bf16_f32 v26, v116, v117
    s_waitcnt lgkmcnt(4)
    v_mfma_f32_32x32x16_bf16 v[64:79], v[148:151], v[52:55], v[64:79]
    v_exp_f32 v118, v118
    v_exp_f32 v119, v119
    v_add_f32 v4, v4, v118
    v_add_f32 v5, v5, v119
    v_cvt_pk_bf16_f32 v27, v118, v119
    ds_write_b128 v2, v[24:27] offset:38912
    s_waitcnt lgkmcnt(3)
    v_mfma_f32_32x32x16_bf16 v[64:79], v[152:155], v[56:59], v[64:79]
    v_exp_f32 v120, v120
    v_exp_f32 v121, v121
    v_add_f32 v4, v4, v120
    v_add_f32 v5, v5, v121
    v_cvt_pk_bf16_f32 v28, v120, v121
    s_waitcnt lgkmcnt(2)
    v_mfma_f32_32x32x16_bf16 v[64:79], v[156:159], v[60:63], v[64:79]
    v_exp_f32 v122, v122
    v_exp_f32 v123, v123
    v_add_f32 v4, v4, v122
    v_add_f32 v5, v5, v123
    v_cvt_pk_bf16_f32 v29, v122, v123
    v_mfma_f32_32x32x16_bf16 v[80:95], v[160:163], v[32:35], 0
    v_exp_f32 v124, v124
    v_exp_f32 v125, v125
    v_add_f32 v4, v4, v124
    v_add_f32 v5, v5, v125
    v_cvt_pk_bf16_f32 v30, v124, v125
    v_mfma_f32_32x32x16_bf16 v[80:95], v[164:167], v[36:39], v[80:95]
    v_exp_f32 v126, v126
    v_exp_f32 v127, v127
    v_add_f32 v4, v4, v126
    v_add_f32 v5, v5, v127
    v_cvt_pk_bf16_f32 v31, v126, v127
    ds_write_b128 v2, v[28:31] offset:39936
    v_add_f32 v6, v4, v5
    ds_write_b32 v3, v6 offset:1024
    v_mfma_f32_32x32x16_bf16 v[80:95], v[168:171], v[40:43], v[80:95]
    v_exp_f32 v64, v64
    v_exp_f32 v65, v65
    v_mov_b32 v4, v64
    v_mov_b32 v5, v65
    v_cvt_pk_bf16_f32 v16, v64, v65
    v_mfma_f32_32x32x16_bf16 v[80:95], v[172:175], v[44:47], v[80:95]
    v_exp_f32 v66, v66
    v_exp_f32 v67, v67
    v_add_f32 v4, v4, v66
    v_add_f32 v5, v5, v67
    v_cvt_pk_bf16_f32 v17, v66, v67
    s_waitcnt lgkmcnt(0)
    s_barrier
    v_mfma_f32_32x32x16_bf16 v[80:95], v[176:179], v[48:51], v[80:95]
    v_exp_f32 v68, v68
    v_exp_f32 v69, v69
    v_add_f32 v4, v4, v68
    v_add_f32 v5, v5, v69
    v_cvt_pk_bf16_f32 v18, v68, v69
    v_mfma_f32_32x32x16_bf16 v[80:95], v[180:183], v[52:55], v[80:95]
    v_exp_f32 v70, v70
    v_exp_f32 v71, v71
    v_add_f32 v4, v4, v70
    v_add_f32 v5, v5, v71
    v_cvt_pk_bf16_f32 v19, v70, v71
    ds_write_b128 v2, v[16:19] offset:0
    v_mfma_f32_32x32x16_bf16 v[80:95], v[184:187], v[56:59], v[80:95]
    v_exp_f32 v72, v72
    v_exp_f32 v73, v73
    v_add_f32 v4, v4, v72
    v_add_f32 v5, v5, v73
    v_cvt_pk_bf16_f32 v20, v72, v73
    v_mfma_f32_32x32x16_bf16 v[80:95], v[188:191], v[60:63], v[80:95]
    v_exp_f32 v74, v74
    v_exp_f32 v75, v75
    v_add_f32 v4, v4, v74
    v_add_f32 v5, v5, v75
    v_cvt_pk_bf16_f32 v21, v74, v75
    v_mfma_f32_32x32x16_bf16 v[96:111], v[192:195], v[32:35], 0
    v_exp_f32 v76, v76
    v_exp_f32 v77, v77
    v_add_f32 v4, v4, v76
    v_add_f32 v5, v5, v77
    v_cvt_pk_bf16_f32 v22, v76, v77
    v_mfma_f32_32x32x16_bf16 v[96:111], v[196:199], v[36:39], v[96:111]
    v_exp_f32 v78, v78
    v_exp_f32 v79, v79
    v_add_f32 v4, v4, v78
    v_add_f32 v5, v5, v79
    v_cvt_pk_bf16_f32 v23, v78, v79
    ds_write_b128 v2, v[20:23] offset:1024
    v_mfma_f32_32x32x16_bf16 v[96:111], v[200:203], v[40:43], v[96:111]
    v_exp_f32 v80, v80
    v_exp_f32 v81, v81
    v_add_f32 v4, v4, v80
    v_add_f32 v5, v5, v81
    v_cvt_pk_bf16_f32 v24, v80, v81
    v_mfma_f32_32x32x16_bf16 v[96:111], v[204:207], v[44:47], v[96:111]
    v_exp_f32 v82, v82
    v_exp_f32 v83, v83
    v_add_f32 v4, v4, v82
    v_add_f32 v5, v5, v83
    v_cvt_pk_bf16_f32 v25, v82, v83
    v_mfma_f32_32x32x16_bf16 v[96:111], v[208:211], v[48:51], v[96:111]
    v_exp_f32 v84, v84
    v_exp_f32 v85, v85
    v_add_f32 v4, v4, v84
    v_add_f32 v5, v5, v85
    v_cvt_pk_bf16_f32 v26, v84, v85
    v_mfma_f32_32x32x16_bf16 v[96:111], v[212:215], v[52:55], v[96:111]
    v_exp_f32 v86, v86
    v_exp_f32 v87, v87
    v_add_f32 v4, v4, v86
    v_add_f32 v5, v5, v87
    v_cvt_pk_bf16_f32 v27, v86, v87
    ds_write_b128 v2, v[24:27] offset:2048
    v_mfma_f32_32x32x16_bf16 v[96:111], v[216:219], v[56:59], v[96:111]
    v_exp_f32 v88, v88
    v_exp_f32 v89, v89
    v_add_f32 v4, v4, v88
    v_add_f32 v5, v5, v89
    v_cvt_pk_bf16_f32 v28, v88, v89
    v_mfma_f32_32x32x16_bf16 v[96:111], v[220:223], v[60:63], v[96:111]
    v_exp_f32 v90, v90
    v_exp_f32 v91, v91
    v_add_f32 v4, v4, v90
    v_add_f32 v5, v5, v91
    v_cvt_pk_bf16_f32 v29, v90, v91
    v_mfma_f32_32x32x16_bf16 v[112:127], v[224:227], v[32:35], 0
    ds_read_b128 v[32:35], v1 offset:8448
    v_exp_f32 v92, v92
    v_exp_f32 v93, v93
    v_add_f32 v4, v4, v92
    v_add_f32 v5, v5, v93
    v_cvt_pk_bf16_f32 v30, v92, v93
    v_mfma_f32_32x32x16_bf16 v[112:127], v[228:231], v[36:39], v[112:127]
    ds_read_b128 v[36:39], v1 offset:9504
    v_exp_f32 v94, v94
    v_exp_f32 v95, v95
    v_add_f32 v4, v4, v94
    v_add_f32 v5, v5, v95
    v_cvt_pk_bf16_f32 v31, v94, v95
    ds_write_b128 v2, v[28:31] offset:3072
    v_mfma_f32_32x32x16_bf16 v[112:127], v[232:235], v[40:43], v[112:127]
    ds_read_b128 v[40:43], v1 offset:10560
    v_exp_f32 v96, v96
    v_exp_f32 v97, v97
    v_add_f32 v4, v4, v96
    v_add_f32 v5, v5, v97
    v_cvt_pk_bf16_f32 v16, v96, v97
    v_mfma_f32_32x32x16_bf16 v[112:127], v[236:239], v[44:47], v[112:127]
    ds_read_b128 v[44:47], v1 offset:11616
    v_exp_f32 v98, v98
    v_exp_f32 v99, v99
    v_add_f32 v4, v4, v98
    v_add_f32 v5, v5, v99
    v_cvt_pk_bf16_f32 v17, v98, v99
    v_mfma_f32_32x32x16_bf16 v[112:127], v[240:243], v[48:51], v[112:127]
    ds_read_b128 v[48:51], v1 offset:12672
    v_exp_f32 v100, v100
    v_exp_f32 v101, v101
    v_add_f32 v4, v4, v100
    v_add_f32 v5, v5, v101
    v_cvt_pk_bf16_f32 v18, v100, v101
    v_mfma_f32_32x32x16_bf16 v[112:127], v[244:247], v[52:55], v[112:127]
    ds_read_b128 v[52:55], v1 offset:13728
    v_exp_f32 v102, v102
    v_exp_f32 v103, v103
    v_add_f32 v4, v4, v102
    v_add_f32 v5, v5, v103
    v_cvt_pk_bf16_f32 v19, v102, v103
    ds_write_b128 v2, v[16:19] offset:4096
    v_mfma_f32_32x32x16_bf16 v[112:127], v[248:251], v[56:59], v[112:127]
    ds_read_b128 v[56:59], v1 offset:14784
    v_exp_f32 v104, v104
    v_exp_f32 v105, v105
    v_add_f32 v4, v4, v104
    v_add_f32 v5, v5, v105
    v_cvt_pk_bf16_f32 v20, v104, v105
    v_mfma_f32_32x32x16_bf16 v[112:127], v[252:255], v[60:63], v[112:127]
    ds_read_b128 v[60:63], v1 offset:15840
    v_exp_f32 v106, v106
    v_exp_f32 v107, v107
    v_add_f32 v4, v4, v106
    v_add_f32 v5, v5, v107
    v_cvt_pk_bf16_f32 v21, v106, v107
    s_sub_u32 s26, s26, 1
    s_cmp_lg_u32 s26, 0
    s_cbranch_scc1 L_qk_loop
    s_waitcnt lgkmcnt(9)
    v_mfma_f32_32x32x16_bf16 v[64:79], v[128:131], v[32:35], 0
    v_exp_f32 v108, v108
    v_exp_f32 v109, v109
    v_add_f32 v4, v4, v108
    v_add_f32 v5, v5, v109
    v_cvt_pk_bf16_f32 v22, v108, v109
    s_waitcnt lgkmcnt(8)
    v_mfma_f32_32x32x16_bf16 v[64:79], v[132:135], v[36:39], v[64:79]
    v_exp_f32 v110, v110
    v_exp_f32 v111, v111
    v_add_f32 v4, v4, v110
    v_add_f32 v5, v5, v111
    v_cvt_pk_bf16_f32 v23, v110, v111
    ds_write_b128 v2, v[20:23] offset:5120
    s_waitcnt lgkmcnt(7)
    v_mfma_f32_32x32x16_bf16 v[64:79], v[136:139], v[40:43], v[64:79]
    v_exp_f32 v112, v112
    v_exp_f32 v113, v113
    v_add_f32 v4, v4, v112
    v_add_f32 v5, v5, v113
    v_cvt_pk_bf16_f32 v24, v112, v113
    s_waitcnt lgkmcnt(6)
    v_mfma_f32_32x32x16_bf16 v[64:79], v[140:143], v[44:47], v[64:79]
    v_exp_f32 v114, v114
    v_exp_f32 v115, v115
    v_add_f32 v4, v4, v114
    v_add_f32 v5, v5, v115
    v_cvt_pk_bf16_f32 v25, v114, v115
    s_waitcnt lgkmcnt(5)
    v_mfma_f32_32x32x16_bf16 v[64:79], v[144:147], v[48:51], v[64:79]
    v_exp_f32 v116, v116
    v_exp_f32 v117, v117
    v_add_f32 v4, v4, v116
    v_add_f32 v5, v5, v117
    v_cvt_pk_bf16_f32 v26, v116, v117
    s_waitcnt lgkmcnt(4)
    v_mfma_f32_32x32x16_bf16 v[64:79], v[148:151], v[52:55], v[64:79]
    v_exp_f32 v118, v118
    v_exp_f32 v119, v119
    v_add_f32 v4, v4, v118
    v_add_f32 v5, v5, v119
    v_cvt_pk_bf16_f32 v27, v118, v119
    ds_write_b128 v2, v[24:27] offset:6144
    s_waitcnt lgkmcnt(3)
    v_mfma_f32_32x32x16_bf16 v[64:79], v[152:155], v[56:59], v[64:79]
    v_exp_f32 v120, v120
    v_exp_f32 v121, v121
    v_add_f32 v4, v4, v120
    v_add_f32 v5, v5, v121
    v_cvt_pk_bf16_f32 v28, v120, v121
    s_waitcnt lgkmcnt(2)
    v_mfma_f32_32x32x16_bf16 v[64:79], v[156:159], v[60:63], v[64:79]
    v_exp_f32 v122, v122
    v_exp_f32 v123, v123
    v_add_f32 v4, v4, v122
    v_add_f32 v5, v5, v123
    v_cvt_pk_bf16_f32 v29, v122, v123
    v_mfma_f32_32x32x16_bf16 v[80:95], v[160:163], v[32:35], 0
    v_exp_f32 v124, v124
    v_exp_f32 v125, v125
    v_add_f32 v4, v4, v124
    v_add_f32 v5, v5, v125
    v_cvt_pk_bf16_f32 v30, v124, v125
    v_mfma_f32_32x32x16_bf16 v[80:95], v[164:167], v[36:39], v[80:95]
    v_exp_f32 v126, v126
    v_exp_f32 v127, v127
    v_add_f32 v4, v4, v126
    v_add_f32 v5, v5, v127
    v_cvt_pk_bf16_f32 v31, v126, v127
    ds_write_b128 v2, v[28:31] offset:7168
    v_add_f32 v6, v4, v5
    ds_write_b32 v3, v6 offset:0
    v_mfma_f32_32x32x16_bf16 v[80:95], v[168:171], v[40:43], v[80:95]
    v_exp_f32 v64, v64
    v_exp_f32 v65, v65
    v_mov_b32 v4, v64
    v_mov_b32 v5, v65
    v_cvt_pk_bf16_f32 v16, v64, v65
    v_mfma_f32_32x32x16_bf16 v[80:95], v[172:175], v[44:47], v[80:95]
    v_exp_f32 v66, v66
    v_exp_f32 v67, v67
    v_add_f32 v4, v4, v66
    v_add_f32 v5, v5, v67
    v_cvt_pk_bf16_f32 v17, v66, v67
    s_waitcnt lgkmcnt(0)
    s_barrier
    v_mfma_f32_32x32x16_bf16 v[80:95], v[176:179], v[48:51], v[80:95]
    v_exp_f32 v68, v68
    v_exp_f32 v69, v69
    v_add_f32 v4, v4, v68
    v_add_f32 v5, v5, v69
    v_cvt_pk_bf16_f32 v18, v68, v69
    v_mfma_f32_32x32x16_bf16 v[80:95], v[180:183], v[52:55], v[80:95]
    v_exp_f32 v70, v70
    v_exp_f32 v71, v71
    v_add_f32 v4, v4, v70
    v_add_f32 v5, v5, v71
    v_cvt_pk_bf16_f32 v19, v70, v71
    ds_write_b128 v2, v[16:19] offset:32768
    v_mfma_f32_32x32x16_bf16 v[80:95], v[184:187], v[56:59], v[80:95]
    v_exp_f32 v72, v72
    v_exp_f32 v73, v73
    v_add_f32 v4, v4, v72
    v_add_f32 v5, v5, v73
    v_cvt_pk_bf16_f32 v20, v72, v73
    v_mfma_f32_32x32x16_bf16 v[80:95], v[188:191], v[60:63], v[80:95]
    v_exp_f32 v74, v74
    v_exp_f32 v75, v75
    v_add_f32 v4, v4, v74
    v_add_f32 v5, v5, v75
    v_cvt_pk_bf16_f32 v21, v74, v75
    v_mfma_f32_32x32x16_bf16 v[96:111], v[192:195], v[32:35], 0
    v_exp_f32 v76, v76
    v_exp_f32 v77, v77
    v_add_f32 v4, v4, v76
    v_add_f32 v5, v5, v77
    v_cvt_pk_bf16_f32 v22, v76, v77
    v_mfma_f32_32x32x16_bf16 v[96:111], v[196:199], v[36:39], v[96:111]
    v_exp_f32 v78, v78
    v_exp_f32 v79, v79
    v_add_f32 v4, v4, v78
    v_add_f32 v5, v5, v79
    v_cvt_pk_bf16_f32 v23, v78, v79
    ds_write_b128 v2, v[20:23] offset:33792
    v_mfma_f32_32x32x16_bf16 v[96:111], v[200:203], v[40:43], v[96:111]
    v_exp_f32 v80, v80
    v_exp_f32 v81, v81
    v_add_f32 v4, v4, v80
    v_add_f32 v5, v5, v81
    v_cvt_pk_bf16_f32 v24, v80, v81
    v_mfma_f32_32x32x16_bf16 v[96:111], v[204:207], v[44:47], v[96:111]
    v_exp_f32 v82, v82
    v_exp_f32 v83, v83
    v_add_f32 v4, v4, v82
    v_add_f32 v5, v5, v83
    v_cvt_pk_bf16_f32 v25, v82, v83
    v_mfma_f32_32x32x16_bf16 v[96:111], v[208:211], v[48:51], v[96:111]
    v_exp_f32 v84, v84
    v_exp_f32 v85, v85
    v_add_f32 v4, v4, v84
    v_add_f32 v5, v5, v85
    v_cvt_pk_bf16_f32 v26, v84, v85
    v_mfma_f32_32x32x16_bf16 v[96:111], v[212:215], v[52:55], v[96:111]
    v_exp_f32 v86, v86
    v_exp_f32 v87, v87
    v_add_f32 v4, v4, v86
    v_add_f32 v5, v5, v87
    v_cvt_pk_bf16_f32 v27, v86, v87
    ds_write_b128 v2, v[24:27] offset:34816
    v_mfma_f32_32x32x16_bf16 v[96:111], v[216:219], v[56:59], v[96:111]
    v_exp_f32 v88, v88
    v_exp_f32 v89, v89
    v_add_f32 v4, v4, v88
    v_add_f32 v5, v5, v89
    v_cvt_pk_bf16_f32 v28, v88, v89
    v_mfma_f32_32x32x16_bf16 v[96:111], v[220:223], v[60:63], v[96:111]
    v_exp_f32 v90, v90
    v_exp_f32 v91, v91
    v_add_f32 v4, v4, v90
    v_add_f32 v5, v5, v91
    v_cvt_pk_bf16_f32 v29, v90, v91
    v_mfma_f32_32x32x16_bf16 v[112:127], v[224:227], v[32:35], 0
    v_exp_f32 v92, v92
    v_exp_f32 v93, v93
    v_add_f32 v4, v4, v92
    v_add_f32 v5, v5, v93
    v_cvt_pk_bf16_f32 v30, v92, v93
    v_mfma_f32_32x32x16_bf16 v[112:127], v[228:231], v[36:39], v[112:127]
    v_exp_f32 v94, v94
    v_exp_f32 v95, v95
    v_add_f32 v4, v4, v94
    v_add_f32 v5, v5, v95
    v_cvt_pk_bf16_f32 v31, v94, v95
    ds_write_b128 v2, v[28:31] offset:35840
    v_mfma_f32_32x32x16_bf16 v[112:127], v[232:235], v[40:43], v[112:127]
    v_exp_f32 v96, v96
    v_exp_f32 v97, v97
    v_add_f32 v4, v4, v96
    v_add_f32 v5, v5, v97
    v_cvt_pk_bf16_f32 v16, v96, v97
    v_mfma_f32_32x32x16_bf16 v[112:127], v[236:239], v[44:47], v[112:127]
    v_exp_f32 v98, v98
    v_exp_f32 v99, v99
    v_add_f32 v4, v4, v98
    v_add_f32 v5, v5, v99
    v_cvt_pk_bf16_f32 v17, v98, v99
    v_mfma_f32_32x32x16_bf16 v[112:127], v[240:243], v[48:51], v[112:127]
    v_exp_f32 v100, v100
    v_exp_f32 v101, v101
    v_add_f32 v4, v4, v100
    v_add_f32 v5, v5, v101
    v_cvt_pk_bf16_f32 v18, v100, v101
    v_mfma_f32_32x32x16_bf16 v[112:127], v[244:247], v[52:55], v[112:127]
    v_exp_f32 v102, v102
    v_exp_f32 v103, v103
    v_add_f32 v4, v4, v102
    v_add_f32 v5, v5, v103
    v_cvt_pk_bf16_f32 v19, v102, v103
    ds_write_b128 v2, v[16:19] offset:36864
    v_mfma_f32_32x32x16_bf16 v[112:127], v[248:251], v[56:59], v[112:127]
    v_exp_f32 v104, v104
    v_exp_f32 v105, v105
    v_add_f32 v4, v4, v104
    v_add_f32 v5, v5, v105
    v_cvt_pk_bf16_f32 v20, v104, v105
    v_mfma_f32_32x32x16_bf16 v[112:127], v[252:255], v[60:63], v[112:127]
    v_exp_f32 v106, v106
    v_exp_f32 v107, v107
    v_add_f32 v4, v4, v106
    v_add_f32 v5, v5, v107
    v_cvt_pk_bf16_f32 v21, v106, v107
    v_exp_f32 v108, v108
    v_exp_f32 v109, v109
    v_add_f32 v4, v4, v108
    v_add_f32 v5, v5, v109
    v_cvt_pk_bf16_f32 v22, v108, v109
    v_exp_f32 v110, v110
    v_exp_f32 v111, v111
    v_add_f32 v4, v4, v110
    v_add_f32 v5, v5, v111
    v_cvt_pk_bf16_f32 v23, v110, v111
    ds_write_b128 v2, v[20:23] offset:37888
    s_nop 7
    s_nop 3
    v_exp_f32 v112, v112
    v_exp_f32 v113, v113
    v_add_f32 v4, v4, v112
    v_add_f32 v5, v5, v113
    v_cvt_pk_bf16_f32 v24, v112, v113
    v_exp_f32 v114, v114
    v_exp_f32 v115, v115
    v_add_f32 v4, v4, v114
    v_add_f32 v5, v5, v115
    v_cvt_pk_bf16_f32 v25, v114, v115
    v_exp_f32 v116, v116
    v_exp_f32 v117, v117
    v_add_f32 v4, v4, v116
    v_add_f32 v5, v5, v117
    v_cvt_pk_bf16_f32 v26, v116, v117
    v_exp_f32 v118, v118
    v_exp_f32 v119, v119
    v_add_f32 v4, v4, v118
    v_add_f32 v5, v5, v119
    v_cvt_pk_bf16_f32 v27, v118, v119
    ds_write_b128 v2, v[24:27] offset:38912
    v_exp_f32 v120, v120
    v_exp_f32 v121, v121
    v_add_f32 v4, v4, v120
    v_add_f32 v5, v5, v121
    v_cvt_pk_bf16_f32 v28, v120, v121
    v_exp_f32 v122, v122
    v_exp_f32 v123, v123
    v_add_f32 v4, v4, v122
    v_add_f32 v5, v5, v123
    v_cvt_pk_bf16_f32 v29, v122, v123
    v_exp_f32 v124, v124
    v_exp_f32 v125, v125
    v_add_f32 v4, v4, v124
    v_add_f32 v5, v5, v125
    v_cvt_pk_bf16_f32 v30, v124, v125
    v_exp_f32 v126, v126
    v_exp_f32 v127, v127
    v_add_f32 v4, v4, v126
    v_add_f32 v5, v5, v127
    v_cvt_pk_bf16_f32 v31, v126, v127
    ds_write_b128 v2, v[28:31] offset:39936
    v_add_f32 v6, v4, v5
    ds_write_b32 v3, v6 offset:1024
    s_waitcnt lgkmcnt(0)
    s_barrier
    s_branch L_join
L_pv:
    s_add_u32 s16, s8, s32
    s_addc_u32 s17, s9, 0
    s_setprio 3
    v_lshrrev_b32 v10, 3, v0
    s_lshl_b32 s30, s25, 3
    v_add_u32 v10, s30, v10
    v_and_b32 v11, 7, v0
    v_lshlrev_b32 v12, 8, v10
    v_lshl_add_u32 v3, v11, 4, v12
    s_lshl_b32 s36, s43, 13
    s_add_u32 s37, s36, 8192
    s_sub_u32 s31, s37, 147456
    s_cmp_ge_u32 s37, 147456
    s_cselect_b32 s37, s31, s37
    buffer_load_dwordx4 v[64:67], v3, s[12:15], s36 offen nt
    buffer_load_dwordx4 v[68:71], v3, s[12:15], s36 offen offset:128 nt
    buffer_load_dwordx4 v[72:75], v3, s[12:15], s37 offen nt
    buffer_load_dwordx4 v[76:79], v3, s[12:15], s37 offen offset:128 nt
    s_setprio 0
    v_and_b32 v8, 31, v0
    v_lshrrev_b32 v9, 5, v0
    v_lshlrev_b32 v1, 4, v0
    v_lshlrev_b32 v10, 2, v8
    v_add_u32 v2, 147968, v10
    v_lshrrev_b32 v10, 3, v0
    s_lshl_b32 s30, s25, 3
    v_add_u32 v10, s30, v10
    v_and_b32 v11, 7, v0
    v_lshlrev_b32 v12, 8, v10
    v_lshl_add_u32 v3, v11, 4, v12
    s_lshl_b32 s36, s43, 13
    s_add_u32 s37, s36, 8192
    s_sub_u32 s31, s37, 147456
    s_cmp_ge_u32 s37, 147456
    s_cselect_b32 s37, s31, s37
    s_add_u32 s38, s37, 8192
    s_sub_u32 s31, s38, 147456
    s_cmp_ge_u32 s38, 147456
    s_cselect_b32 s38, s31, s38
    v_mul_u32_u24 v12, 528, v11
    v_lshl_add_u32 v12, v10, 4, v12
    v_add_u32 v4, 131072, v12
    s_lshl_b32 s30, s25, 6
    v_lshlrev_b32 v12, 8, v8
    v_lshl_add_u32 v12, v9, 4, v12
    v_add_u32 v5, s30, v12
    v_lshrrev_b32 v10, 2, v0
    v_and_b32 v11, 3, v0
    v_lshlrev_b32 v12, 8, v10
    v_lshl_add_u32 v12, v11, 4, v12
    v_add_u32 v49, s30, v12
    v_and_b32 v10, 3, v10
    v_lshl_add_u32 v10, v9, 2, v10
    v_lshlrev_b32 v10, 6, v10
    v_bfe_u32 v12, v0, 4, 1
    v_lshl_add_u32 v10, v12, 5, v10
    v_and_b32 v12, 1, v11
    v_lshl_add_u32 v10, v12, 4, v10
    v_lshrrev_b32 v12, 1, v11
    v_lshl_add_u32 v10, v12, 3, v10
    s_lshl_b32 s39, s25, 14
    s_add_u32 s39, s39, 65536
    v_add_u32 v48, s39, v10
    v_lshlrev_b32 v10, 2, v8
    v_add_u32 v0, 148992, v10
    s_mov_b32 s27, 0
    s_mov_b32 s33, s43
    s_sub_u32 s35, s36, 8192
    s_add_u32 s28, s38, 8192
    s_sub_u32 s31, s28, 147456
    s_cmp_ge_u32 s28, 147456
    s_cselect_b32 s28, s31, s28
    s_add_u32 s34, s28, 8192
    s_sub_u32 s31, s34, 147456
    s_cmp_ge_u32 s34, 147456
    s_cselect_b32 s34, s31, s34
    s_mov_b32 s48, 14
    s_waitcnt vmcnt(2)
    ds_write_b128 v4, v[64:67] offset:0
    ds_write_b128 v4, v[68:71] offset:4224
    s_waitcnt vmcnt(0)
    ds_write_b128 v4, v[72:75] offset:8448
    ds_write_b128 v4, v[76:79] offset:12672
    s_waitcnt lgkmcnt(0)
    buffer_load_dwordx4 v[80:83], v3, s[12:15], s38 offen nt
    buffer_load_dwordx4 v[84:87], v3, s[12:15], s38 offen offset:128 nt
    s_barrier
    s_add_u32 m0, s39, 0
    s_xor_b32 s30, s42, 0
    buffer_load_dwordx4 v49, s[16:19], s30 offen nt lds
    s_add_u32 m0, s39, 1024
    s_xor_b32 s30, s42, 4096
    buffer_load_dwordx4 v49, s[16:19], s30 offen nt lds
    s_add_u32 m0, s39, 2048
    s_xor_b32 s30, s42, 8192
    buffer_load_dwordx4 v49, s[16:19], s30 offen nt lds
    s_add_u32 m0, s39, 3072
    s_xor_b32 s30, s42, 12288
    buffer_load_dwordx4 v49, s[16:19], s30 offen nt lds
    s_barrier
    s_add_u32 m0, s39, 4096
    s_xor_b32 s30, s42, 16384
    buffer_load_dwordx4 v49, s[16:19], s30 offen nt lds
    s_add_u32 m0, s39, 5120
    s_xor_b32 s30, s42, 20480
    buffer_load_dwordx4 v49, s[16:19], s30 offen nt lds
    s_add_u32 m0, s39, 6144
    s_xor_b32 s30, s42, 24576
    buffer_load_dwordx4 v49, s[16:19], s30 offen nt lds
    s_add_u32 m0, s39, 7168
    s_xor_b32 s30, s42, 28672
    buffer_load_dwordx4 v49, s[16:19], s30 offen nt lds
    s_add_u32 m0, s39, 8192
    s_xor_b32 s30, s42, 32768
    buffer_load_dwordx4 v49, s[16:19], s30 offen nt lds
    s_add_u32 m0, s39, 9216
    s_xor_b32 s30, s42, 36864
    buffer_load_dwordx4 v49, s[16:19], s30 offen nt lds
    s_add_u32 m0, s39, 10240
    s_xor_b32 s30, s42, 40960
    buffer_load_dwordx4 v49, s[16:19], s30 offen nt lds
    s_add_u32 m0, s39, 11264
    s_xor_b32 s30, s42, 45056
    buffer_load_dwordx4 v49, s[16:19], s30 offen nt lds
    s_add_u32 m0, s39, 12288
    s_xor_b32 s30, s42, 49152
    buffer_load_dwordx4 v49, s[16:19], s30 offen nt lds
    s_add_u32 m0, s39, 13312
    s_xor_b32 s30, s42, 53248
    buffer_load_dwordx4 v49, s[16:19], s30 offen nt lds
    s_add_u32 m0, s39, 14336
    s_xor_b32 s30, s42, 57344
    buffer_load_dwordx4 v49, s[16:19], s30 offen nt lds
    s_add_u32 m0, s39, 15360
    s_xor_b32 s30, s42, 61440
    buffer_load_dwordx4 v49, s[16:19], s30 offen nt lds
    s_waitcnt vmcnt(16)
    ds_write_b128 v4, v[80:83] offset:0
    ds_write_b128 v4, v[84:87] offset:4224
    buffer_load_dwordx4 v[24:27], v3, s[12:15], s28 offen nt
    buffer_load_dwordx4 v[28:31], v3, s[12:15], s28 offen offset:128 nt
    s_waitcnt vmcnt(14)
    ds_read_b64_tr_b16 v[128:129], v48 offset:0
    ds_read_b64_tr_b16 v[130:131], v48 offset:512
    ds_read_b64_tr_b16 v[132:133], v48 offset:1024
    ds_read_b64_tr_b16 v[134:135], v48 offset:1536
    ds_read_b64_tr_b16 v[136:137], v48 offset:2048
    ds_read_b64_tr_b16 v[138:139], v48 offset:2560
    ds_read_b64_tr_b16 v[140:141], v48 offset:3072
    ds_read_b64_tr_b16 v[142:143], v48 offset:3584
    s_waitcnt lgkmcnt(0)
    s_add_u32 m0, s39, 0
    s_xor_b32 s30, s42, 65536
    buffer_load_dwordx4 v49, s[16:19], s30 offen nt lds
    s_add_u32 m0, s39, 1024
    s_xor_b32 s30, s42, 69632
    buffer_load_dwordx4 v49, s[16:19], s30 offen nt lds
    s_add_u32 m0, s39, 2048
    s_xor_b32 s30, s42, 73728
    buffer_load_dwordx4 v49, s[16:19], s30 offen nt lds
    s_add_u32 m0, s39, 3072
    s_xor_b32 s30, s42, 77824
    buffer_load_dwordx4 v49, s[16:19], s30 offen nt lds
    s_waitcnt vmcnt(14)
    ds_read_b64_tr_b16 v[144:145], v48 offset:4096
    ds_read_b64_tr_b16 v[146:147], v48 offset:4608
    ds_read_b64_tr_b16 v[148:149], v48 offset:5120
    ds_read_b64_tr_b16 v[150:151], v48 offset:5632
    ds_read_b64_tr_b16 v[152:153], v48 offset:6144
    ds_read_b64_tr_b16 v[154:155], v48 offset:6656
    ds_read_b64_tr_b16 v[156:157], v48 offset:7168
    ds_read_b64_tr_b16 v[158:159], v48 offset:7680
    s_waitcnt lgkmcnt(0)
    s_add_u32 m0, s39, 4096
    s_xor_b32 s30, s42, 81920
    buffer_load_dwordx4 v49, s[16:19], s30 offen nt lds
    s_add_u32 m0, s39, 5120
    s_xor_b32 s30, s42, 86016
    buffer_load_dwordx4 v49, s[16:19], s30 offen nt lds
    s_add_u32 m0, s39, 6144
    s_xor_b32 s30, s42, 90112
    buffer_load_dwordx4 v49, s[16:19], s30 offen nt lds
    s_add_u32 m0, s39, 7168
    s_xor_b32 s30, s42, 94208
    buffer_load_dwordx4 v49, s[16:19], s30 offen nt lds
    s_waitcnt vmcnt(14)
    ds_read_b64_tr_b16 v[160:161], v48 offset:8192
    ds_read_b64_tr_b16 v[162:163], v48 offset:8704
    ds_read_b64_tr_b16 v[164:165], v48 offset:9216
    ds_read_b64_tr_b16 v[166:167], v48 offset:9728
    ds_read_b64_tr_b16 v[168:169], v48 offset:10240
    ds_read_b64_tr_b16 v[170:171], v48 offset:10752
    ds_read_b64_tr_b16 v[172:173], v48 offset:11264
    ds_read_b64_tr_b16 v[174:175], v48 offset:11776
    s_waitcnt lgkmcnt(0)
    s_add_u32 m0, s39, 8192
    s_xor_b32 s30, s42, 98304
    buffer_load_dwordx4 v49, s[16:19], s30 offen nt lds
    s_add_u32 m0, s39, 9216
    s_xor_b32 s30, s42, 102400
    buffer_load_dwordx4 v49, s[16:19], s30 offen nt lds
    s_add_u32 m0, s39, 10240
    s_xor_b32 s30, s42, 106496
    buffer_load_dwordx4 v49, s[16:19], s30 offen nt lds
    s_add_u32 m0, s39, 11264
    s_xor_b32 s30, s42, 110592
    buffer_load_dwordx4 v49, s[16:19], s30 offen nt lds
    s_waitcnt vmcnt(14)
    ds_read_b64_tr_b16 v[176:177], v48 offset:12288
    ds_read_b64_tr_b16 v[178:179], v48 offset:12800
    ds_read_b64_tr_b16 v[180:181], v48 offset:13312
    ds_read_b64_tr_b16 v[182:183], v48 offset:13824
    ds_read_b64_tr_b16 v[184:185], v48 offset:14336
    ds_read_b64_tr_b16 v[186:187], v48 offset:14848
    ds_read_b64_tr_b16 v[188:189], v48 offset:15360
    ds_read_b64_tr_b16 v[190:191], v48 offset:15872
    s_waitcnt lgkmcnt(0)
    s_add_u32 m0, s39, 12288
    s_xor_b32 s30, s42, 114688
    buffer_load_dwordx4 v49, s[16:19], s30 offen nt lds
    s_add_u32 m0, s39, 13312
    s_xor_b32 s30, s42, 118784
    buffer_load_dwordx4 v49, s[16:19], s30 offen nt lds
    s_add_u32 m0, s39, 14336
    s_xor_b32 s30, s42, 122880
    buffer_load_dwordx4 v49, s[16:19], s30 offen nt lds
    s_add_u32 m0, s39, 15360
    s_xor_b32 s30, s42, 126976
    buffer_load_dwordx4 v49, s[16:19], s30 offen nt lds
    s_waitcnt lgkmcnt(0)
    s_barrier
    ds_read_b128 v[64:67], v1 offset:0
    ds_read2_b32 v[8:9], v2 offset0:0 offset1:32
    ds_read2_b32 v[10:11], v2 offset0:64 offset1:96
    ds_read_b128 v[68:71], v1 offset:1024
    ds_read2_b32 v[12:13], v2 offset0:128 offset1:160
    ds_read2_b32 v[14:15], v2 offset0:192 offset1:224
    buffer_load_dwordx4 v[16:19], v3, s[12:15], s34 offen nt
    buffer_load_dwordx4 v[20:23], v3, s[12:15], s34 offen offset:128 nt
    ds_read_b128 v[72:75], v1 offset:2048
    ds_read_b128 v[76:79], v1 offset:3072
    ds_read_b128 v[80:83], v1 offset:4096
    ds_read_b128 v[84:87], v1 offset:5120
    s_waitcnt lgkmcnt(4)
    v_add_f32 v8, v8, v9
    v_add_f32 v10, v10, v11
    v_add_f32 v12, v12, v13
    v_add_f32 v14, v14, v15
    ds_read_b128 v[88:91], v1 offset:6144
    ds_read_b128 v[92:95], v1 offset:7168
    v_add_f32 v8, v8, v10
    v_add_f32 v12, v12, v14
    v_add_f32 v8, v8, v12
    v_rcp_f32 v6, v8
    ds_read_b128 v[96:99], v1 offset:8192
    ds_read_b128 v[100:103], v1 offset:9216
    v_cmp_nle_f32 vcc, s46, v8
    v_cmp_nge_f32 s[30:31], s47, v8
    s_nop 1
    s_or_b64 vcc, vcc, s[30:31]
    s_cmp_lg_u64 vcc, 0
    s_cselect_b32 s30, 1, 0
    s_lshl_b32 s30, s30, s33
    s_or_b32 s27, s27, s30
    s_add_u32 s33, s33, 1
    s_cmp_eq_u32 s33, 18
    s_cselect_b32 s33, 0, s33
    ds_read_b128 v[104:107], v1 offset:10240
    ds_read_b128 v[108:111], v1 offset:11264
    v_mfma_f32_32x32x16_bf16 v[32:47], v[128:131], v[64:67], 0
    ds_read_b128 v[112:115], v1 offset:12288
    v_mfma_f32_32x32x16_bf16 v[32:47], v[132:135], v[68:71], v[32:47]
    ds_read_b128 v[116:119], v1 offset:13312
    s_waitcnt lgkmcnt(10)
    v_mfma_f32_32x32x16_bf16 v[32:47], v[136:139], v[72:75], v[32:47]
    ds_read_b128 v[120:123], v1 offset:14336
    v_mfma_f32_32x32x16_bf16 v[32:47], v[140:143], v[76:79], v[32:47]
    ds_read_b128 v[124:127], v1 offset:15360
    s_waitcnt lgkmcnt(10)
    v_mfma_f32_32x32x16_bf16 v[32:47], v[144:147], v[80:83], v[32:47]
    ds_read_b128 v[64:67], v1 offset:16384
    v_mfma_f32_32x32x16_bf16 v[32:47], v[148:151], v[84:87], v[32:47]
    ds_read_b128 v[68:71], v1 offset:17408
    s_waitcnt lgkmcnt(10)
    v_mfma_f32_32x32x16_bf16 v[32:47], v[152:155], v[88:91], v[32:47]
    ds_read_b128 v[72:75], v1 offset:18432
    v_mfma_f32_32x32x16_bf16 v[32:47], v[156:159], v[92:95], v[32:47]
    ds_read_b128 v[76:79], v1 offset:19456
    s_waitcnt lgkmcnt(10)
    v_mfma_f32_32x32x16_bf16 v[32:47], v[160:163], v[96:99], v[32:47]
    ds_read_b128 v[80:83], v1 offset:20480
    v_mfma_f32_32x32x16_bf16 v[32:47], v[164:167], v[100:103], v[32:47]
    ds_read_b128 v[84:87], v1 offset:21504
    s_waitcnt lgkmcnt(10)
    v_mfma_f32_32x32x16_bf16 v[32:47], v[168:171], v[104:107], v[32:47]
    ds_read_b128 v[88:91], v1 offset:22528
    v_mfma_f32_32x32x16_bf16 v[32:47], v[172:175], v[108:111], v[32:47]
    ds_read_b128 v[92:95], v1 offset:23552
    s_waitcnt vmcnt(14)
    ds_read_b64_tr_b16 v[192:193], v48 offset:0
    ds_read_b64_tr_b16 v[194:195], v48 offset:512
    ds_read_b64_tr_b16 v[196:197], v48 offset:1024
    ds_read_b64_tr_b16 v[198:199], v48 offset:1536
    ds_read_b64_tr_b16 v[200:201], v48 offset:2048
    ds_read_b64_tr_b16 v[202:203], v48 offset:2560
    ds_read_b64_tr_b16 v[204:205], v48 offset:3072
    ds_read_b64_tr_b16 v[206:207], v48 offset:3584
    s_waitcnt lgkmcnt(15)
    v_mfma_f32_32x32x16_bf16 v[32:47], v[176:179], v[112:115], v[32:47]
    ds_read_b128 v[96:99], v1 offset:24576
    v_mfma_f32_32x32x16_bf16 v[32:47], v[180:183], v[116:119], v[32:47]
    ds_read_b128 v[100:103], v1 offset:25600
    v_mfma_f32_32x32x16_bf16 v[32:47], v[184:187], v[120:123], v[32:47]
    ds_read_b128 v[104:107], v1 offset:26624
    v_mfma_f32_32x32x16_bf16 v[32:47], v[188:191], v[124:127], v[32:47]
    ds_read_b128 v[108:111], v1 offset:27648
    s_waitcnt vmcnt(10)
    ds_read_b64_tr_b16 v[208:209], v48 offset:4096
    ds_read_b64_tr_b16 v[210:211], v48 offset:4608
    ds_read_b64_tr_b16 v[212:213], v48 offset:5120
    ds_read_b64_tr_b16 v[214:215], v48 offset:5632
    ds_read_b64_tr_b16 v[216:217], v48 offset:6144
    ds_read_b64_tr_b16 v[218:219], v48 offset:6656
    ds_read_b64_tr_b16 v[220:221], v48 offset:7168
    ds_read_b64_tr_b16 v[222:223], v48 offset:7680
    s_waitcnt lgkmcnt(12)
    v_mfma_f32_32x32x16_bf16 v[32:47], v[192:195], v[64:67], v[32:47]
    ds_read_b128 v[112:115], v1 offset:28672
    ds_write_b128 v4, v[24:27] offset:8448
    ds_write_b128 v4, v[28:31] offset:12672
    v_mfma_f32_32x32x16_bf16 v[32:47], v[196:199], v[68:71], v[32:47]
    ds_read_b128 v[116:119], v1 offset:29696
    v_mfma_f32_32x32x16_bf16 v[32:47], v[200:203], v[72:75], v[32:47]
    ds_read_b128 v[120:123], v1 offset:30720
    v_mfma_f32_32x32x16_bf16 v[32:47], v[204:207], v[76:79], v[32:47]
    ds_read_b128 v[124:127], v1 offset:31744
    s_waitcnt vmcnt(6)
    ds_read_b64_tr_b16 v[224:225], v48 offset:8192
    ds_read_b64_tr_b16 v[226:227], v48 offset:8704
    ds_read_b64_tr_b16 v[228:229], v48 offset:9216
    ds_read_b64_tr_b16 v[230:231], v48 offset:9728
    ds_read_b64_tr_b16 v[232:233], v48 offset:10240
    ds_read_b64_tr_b16 v[234:235], v48 offset:10752
    ds_read_b64_tr_b16 v[236:237], v48 offset:11264
    ds_read_b64_tr_b16 v[238:239], v48 offset:11776
    s_waitcnt lgkmcnt(14)
    v_mfma_f32_32x32x16_bf16 v[32:47], v[208:211], v[80:83], v[32:47]
    s_add_u32 s34, s34, 8192
    s_sub_u32 s31, s34, 147456
    s_cmp_ge_u32 s34, 147456
    s_cselect_b32 s34, s31, s34
    s_sub_u32 s48, s48, 1
    s_cmp_le_i32 s48, 0
    s_cselect_b32 s34, 147456, s34
    v_mfma_f32_32x32x16_bf16 v[32:47], v[212:215], v[84:87], v[32:47]
    s_add_u32 s35, s35, 8192
    s_sub_u32 s31, s35, 147456
    s_cmp_ge_u32 s35, 147456
    s_cselect_b32 s35, s31, s35
    v_mfma_f32_32x32x16_bf16 v[32:47], v[216:219], v[88:91], v[32:47]
    v_mfma_f32_32x32x16_bf16 v[32:47], v[220:223], v[92:95], v[32:47]
    s_waitcnt vmcnt(2)
    ds_read_b64_tr_b16 v[240:241], v48 offset:12288
    ds_read_b64_tr_b16 v[242:243], v48 offset:12800
    ds_read_b64_tr_b16 v[244:245], v48 offset:13312
    ds_read_b64_tr_b16 v[246:247], v48 offset:13824
    ds_read_b64_tr_b16 v[248:249], v48 offset:14336
    ds_read_b64_tr_b16 v[250:251], v48 offset:14848
    ds_read_b64_tr_b16 v[252:253], v48 offset:15360
    ds_read_b64_tr_b16 v[254:255], v48 offset:15872
    s_waitcnt lgkmcnt(0)
    s_barrier
    s_mov_b32 s26, 8
L_pv_loop:
    v_mfma_f32_32x32x16_bf16 v[32:47], v[224:227], v[96:99], v[32:47]
    ds_read_b128 v[64:67], v1 offset:32768
    ds_read2_b32 v[8:9], v0 offset0:0 offset1:32
    ds_read2_b32 v[10:11], v0 offset0:64 offset1:96
    v_mfma_f32_32x32x16_bf16 v[32:47], v[228:231], v[100:103], v[32:47]
    ds_read_b128 v[68:71], v1 offset:33792
    ds_read2_b32 v[12:13], v0 offset0:128 offset1:160
    ds_read2_b32 v[14:15], v0 offset0:192 offset1:224
    buffer_load_dwordx4 v[24:27], v3, s[12:15], s34 offen nt
    buffer_load_dwordx4 v[28:31], v3, s[12:15], s34 offen offset:128 nt
    v_mfma_f32_32x32x16_bf16 v[32:47], v[232:235], v[104:107], v[32:47]
    ds_read_b128 v[72:75], v1 offset:34816
    v_mfma_f32_32x32x16_bf16 v[32:47], v[236:239], v[108:111], v[32:47]
    ds_read_b128 v[76:79], v1 offset:35840
    v_mfma_f32_32x32x16_bf16 v[32:47], v[240:243], v[112:115], v[32:47]
    ds_read_b128 v[80:83], v1 offset:36864
    ds_read_b128 v[84:87], v1 offset:37888
    s_waitcnt lgkmcnt(4)
    v_add_f32 v8, v8, v9
    v_add_f32 v10, v10, v11
    v_add_f32 v12, v12, v13
    v_add_f32 v14, v14, v15
    v_mfma_f32_32x32x16_bf16 v[32:47], v[244:247], v[116:119], v[32:47]
    ds_read_b128 v[88:91], v1 offset:38912
    ds_read_b128 v[92:95], v1 offset:39936
    v_add_f32 v8, v8, v10
    v_add_f32 v12, v12, v14
    v_add_f32 v8, v8, v12
    v_rcp_f32 v7, v8
    v_mfma_f32_32x32x16_bf16 v[32:47], v[248:251], v[120:123], v[32:47]
    ds_read_b128 v[96:99], v1 offset:40960
    ds_read_b128 v[100:103], v1 offset:41984
    v_cmp_nle_f32 vcc, s46, v8
    v_cmp_nge_f32 s[30:31], s47, v8
    s_nop 1
    s_or_b64 vcc, vcc, s[30:31]
    s_cmp_lg_u64 vcc, 0
    s_cselect_b32 s30, 1, 0
    s_lshl_b32 s30, s30, s33
    s_or_b32 s27, s27, s30
    s_add_u32 s33, s33, 1
    s_cmp_eq_u32 s33, 18
    s_cselect_b32 s33, 0, s33
    v_mfma_f32_32x32x16_bf16 v[32:47], v[252:255], v[124:127], v[32:47]
    ds_read_b128 v[104:107], v1 offset:43008
    ds_read_b128 v[108:111], v1 offset:44032
    v_mfma_f32_32x32x16_bf16 v[48:63], v[128:131], v[64:67], 0
    ds_read_b128 v[112:115], v1 offset:45056
    v_mfma_f32_32x32x16_bf16 v[48:63], v[132:135], v[68:71], v[48:63]
    ds_read_b128 v[116:119], v1 offset:46080
    s_waitcnt lgkmcnt(10)
    v_mfma_f32_32x32x16_bf16 v[48:63], v[136:139], v[72:75], v[48:63]
    ds_read_b128 v[120:123], v1 offset:47104
    v_mfma_f32_32x32x16_bf16 v[48:63], v[140:143], v[76:79], v[48:63]
    ds_read_b128 v[124:127], v1 offset:48128
    s_waitcnt lgkmcnt(10)
    v_mfma_f32_32x32x16_bf16 v[48:63], v[144:147], v[80:83], v[48:63]
    ds_read_b128 v[64:67], v1 offset:49152
    v_mfma_f32_32x32x16_bf16 v[48:63], v[148:151], v[84:87], v[48:63]
    ds_read_b128 v[68:71], v1 offset:50176
    v_mul_f32 v32, v32, v6
    v_mul_f32 v33, v33, v6
    v_cvt_pk_bf16_f32 v32, v32, v33
    s_waitcnt lgkmcnt(10)
    v_mfma_f32_32x32x16_bf16 v[48:63], v[152:155], v[88:91], v[48:63]
    ds_read_b128 v[72:75], v1 offset:51200
    v_mul_f32 v34, v34, v6
    v_mul_f32 v35, v35, v6
    v_cvt_pk_bf16_f32 v33, v34, v35
    v_mfma_f32_32x32x16_bf16 v[48:63], v[156:159], v[92:95], v[48:63]
    ds_read_b128 v[76:79], v1 offset:52224
    v_mul_f32 v36, v36, v6
    v_mul_f32 v37, v37, v6
    v_cvt_pk_bf16_f32 v34, v36, v37
    s_waitcnt lgkmcnt(10)
    v_mfma_f32_32x32x16_bf16 v[48:63], v[160:163], v[96:99], v[48:63]
    ds_read_b128 v[80:83], v1 offset:53248
    v_mul_f32 v38, v38, v6
    v_mul_f32 v39, v39, v6
    v_cvt_pk_bf16_f32 v35, v38, v39
    v_mfma_f32_32x32x16_bf16 v[48:63], v[164:167], v[100:103], v[48:63]
    ds_read_b128 v[84:87], v1 offset:54272
    v_mul_f32 v40, v40, v6
    v_mul_f32 v41, v41, v6
    v_cvt_pk_bf16_f32 v36, v40, v41
    s_waitcnt lgkmcnt(10)
    v_mfma_f32_32x32x16_bf16 v[48:63], v[168:171], v[104:107], v[48:63]
    ds_read_b128 v[88:91], v1 offset:55296
    v_mul_f32 v42, v42, v6
    v_mul_f32 v43, v43, v6
    v_cvt_pk_bf16_f32 v37, v42, v43
    v_mfma_f32_32x32x16_bf16 v[48:63], v[172:175], v[108:111], v[48:63]
    ds_read_b128 v[92:95], v1 offset:56320
    v_mul_f32 v44, v44, v6
    v_mul_f32 v45, v45, v6
    v_cvt_pk_bf16_f32 v38, v44, v45
    s_waitcnt lgkmcnt(10)
    v_mfma_f32_32x32x16_bf16 v[48:63], v[176:179], v[112:115], v[48:63]
    ds_read_b128 v[96:99], v1 offset:57344
    v_mul_f32 v46, v46, v6
    v_mul_f32 v47, v47, v6
    v_cvt_pk_bf16_f32 v39, v46, v47
    v_mfma_f32_32x32x16_bf16 v[48:63], v[180:183], v[116:119], v[48:63]
    ds_read_b128 v[100:103], v1 offset:58368
    s_waitcnt lgkmcnt(10)
    v_mfma_f32_32x32x16_bf16 v[48:63], v[184:187], v[120:123], v[48:63]
    ds_read_b128 v[104:107], v1 offset:59392
    buffer_store_dwordx4 v[32:35], v5, s[20:23], s35 offen nt
    buffer_store_dwordx4 v[36:39], v5, s[20:23], s35 offen offset:32 nt
    v_mfma_f32_32x32x16_bf16 v[48:63], v[188:191], v[124:127], v[48:63]
    ds_read_b128 v[108:111], v1 offset:60416
    s_waitcnt lgkmcnt(10)
    v_mfma_f32_32x32x16_bf16 v[48:63], v[192:195], v[64:67], v[48:63]
    ds_read_b128 v[112:115], v1 offset:61440
    s_waitcnt vmcnt(4)
    ds_write_b128 v4, v[16:19] offset:0
    ds_write_b128 v4, v[20:23] offset:4224
    v_mfma_f32_32x32x16_bf16 v[48:63], v[196:199], v[68:71], v[48:63]
    ds_read_b128 v[116:119], v1 offset:62464
    s_waitcnt lgkmcnt(12)
    v_mfma_f32_32x32x16_bf16 v[48:63], v[200:203], v[72:75], v[48:63]
    ds_read_b128 v[120:123], v1 offset:63488
    v_mfma_f32_32x32x16_bf16 v[48:63], v[204:207], v[76:79], v[48:63]
    ds_read_b128 v[124:127], v1 offset:64512
    s_waitcnt lgkmcnt(12)
    v_mfma_f32_32x32x16_bf16 v[48:63], v[208:211], v[80:83], v[48:63]
    s_add_u32 s34, s34, 8192
    s_sub_u32 s31, s34, 147456
    s_cmp_ge_u32 s34, 147456
    s_cselect_b32 s34, s31, s34
    s_sub_u32 s48, s48, 1
    s_cmp_le_i32 s48, 0
    s_cselect_b32 s34, 147456, s34
    v_mfma_f32_32x32x16_bf16 v[48:63], v[212:215], v[84:87], v[48:63]
    s_add_u32 s35, s35, 8192
    s_sub_u32 s31, s35, 147456
    s_cmp_ge_u32 s35, 147456
    s_cselect_b32 s35, s31, s35
    s_waitcnt lgkmcnt(10)
    v_mfma_f32_32x32x16_bf16 v[48:63], v[216:219], v[88:91], v[48:63]
    v_mfma_f32_32x32x16_bf16 v[48:63], v[220:223], v[92:95], v[48:63]
    s_waitcnt lgkmcnt(0)
    s_barrier
    v_mfma_f32_32x32x16_bf16 v[48:63], v[224:227], v[96:99], v[48:63]
    ds_read_b128 v[64:67], v1 offset:0
    ds_read2_b32 v[8:9], v2 offset0:0 offset1:32
    ds_read2_b32 v[10:11], v2 offset0:64 offset1:96
    v_mfma_f32_32x32x16_bf16 v[48:63], v[228:231], v[100:103], v[48:63]
    ds_read_b128 v[68:71], v1 offset:1024
    ds_read2_b32 v[12:13], v2 offset0:128 offset1:160
    ds_read2_b32 v[14:15], v2 offset0:192 offset1:224
    buffer_load_dwordx4 v[16:19], v3, s[12:15], s34 offen nt
    buffer_load_dwordx4 v[20:23], v3, s[12:15], s34 offen offset:128 nt
    v_mfma_f32_32x32x16_bf16 v[48:63], v[232:235], v[104:107], v[48:63]
    ds_read_b128 v[72:75], v1 offset:2048
    v_mfma_f32_32x32x16_bf16 v[48:63], v[236:239], v[108:111], v[48:63]
    ds_read_b128 v[76:79], v1 offset:3072
    v_mfma_f32_32x32x16_bf16 v[48:63], v[240:243], v[112:115], v[48:63]
    ds_read_b128 v[80:83], v1 offset:4096
    ds_read_b128 v[84:87], v1 offset:5120
    s_waitcnt lgkmcnt(4)
    v_add_f32 v8, v8, v9
    v_add_f32 v10, v10, v11
    v_add_f32 v12, v12, v13
    v_add_f32 v14, v14, v15
    v_mfma_f32_32x32x16_bf16 v[48:63], v[244:247], v[116:119], v[48:63]
    ds_read_b128 v[88:91], v1 offset:6144
    ds_read_b128 v[92:95], v1 offset:7168
    v_add_f32 v8, v8, v10
    v_add_f32 v12, v12, v14
    v_add_f32 v8, v8, v12
    v_rcp_f32 v6, v8
    v_mfma_f32_32x32x16_bf16 v[48:63], v[248:251], v[120:123], v[48:63]
    ds_read_b128 v[96:99], v1 offset:8192
    ds_read_b128 v[100:103], v1 offset:9216
    v_cmp_nle_f32 vcc, s46, v8
    v_cmp_nge_f32 s[30:31], s47, v8
    s_nop 1
    s_or_b64 vcc, vcc, s[30:31]
    s_cmp_lg_u64 vcc, 0
    s_cselect_b32 s30, 1, 0
    s_lshl_b32 s30, s30, s33
    s_or_b32 s27, s27, s30
    s_add_u32 s33, s33, 1
    s_cmp_eq_u32 s33, 18
    s_cselect_b32 s33, 0, s33
    v_mfma_f32_32x32x16_bf16 v[48:63], v[252:255], v[124:127], v[48:63]
    ds_read_b128 v[104:107], v1 offset:10240
    ds_read_b128 v[108:111], v1 offset:11264
    v_mfma_f32_32x32x16_bf16 v[32:47], v[128:131], v[64:67], 0
    ds_read_b128 v[112:115], v1 offset:12288
    v_mfma_f32_32x32x16_bf16 v[32:47], v[132:135], v[68:71], v[32:47]
    ds_read_b128 v[116:119], v1 offset:13312
    s_waitcnt lgkmcnt(10)
    v_mfma_f32_32x32x16_bf16 v[32:47], v[136:139], v[72:75], v[32:47]
    ds_read_b128 v[120:123], v1 offset:14336
    v_mfma_f32_32x32x16_bf16 v[32:47], v[140:143], v[76:79], v[32:47]
    ds_read_b128 v[124:127], v1 offset:15360
    s_waitcnt lgkmcnt(10)
    v_mfma_f32_32x32x16_bf16 v[32:47], v[144:147], v[80:83], v[32:47]
    ds_read_b128 v[64:67], v1 offset:16384
    v_mfma_f32_32x32x16_bf16 v[32:47], v[148:151], v[84:87], v[32:47]
    ds_read_b128 v[68:71], v1 offset:17408
    v_mul_f32 v48, v48, v7
    v_mul_f32 v49, v49, v7
    v_cvt_pk_bf16_f32 v48, v48, v49
    s_waitcnt lgkmcnt(10)
    v_mfma_f32_32x32x16_bf16 v[32:47], v[152:155], v[88:91], v[32:47]
    ds_read_b128 v[72:75], v1 offset:18432
    v_mul_f32 v50, v50, v7
    v_mul_f32 v51, v51, v7
    v_cvt_pk_bf16_f32 v49, v50, v51
    v_mfma_f32_32x32x16_bf16 v[32:47], v[156:159], v[92:95], v[32:47]
    ds_read_b128 v[76:79], v1 offset:19456
    v_mul_f32 v52, v52, v7
    v_mul_f32 v53, v53, v7
    v_cvt_pk_bf16_f32 v50, v52, v53
    s_waitcnt lgkmcnt(10)
    v_mfma_f32_32x32x16_bf16 v[32:47], v[160:163], v[96:99], v[32:47]
    ds_read_b128 v[80:83], v1 offset:20480
    v_mul_f32 v54, v54, v7
    v_mul_f32 v55, v55, v7
    v_cvt_pk_bf16_f32 v51, v54, v55
    v_mfma_f32_32x32x16_bf16 v[32:47], v[164:167], v[100:103], v[32:47]
    ds_read_b128 v[84:87], v1 offset:21504
    v_mul_f32 v56, v56, v7
    v_mul_f32 v57, v57, v7
    v_cvt_pk_bf16_f32 v52, v56, v57
    s_waitcnt lgkmcnt(10)
    v_mfma_f32_32x32x16_bf16 v[32:47], v[168:171], v[104:107], v[32:47]
    ds_read_b128 v[88:91], v1 offset:22528
    v_mul_f32 v58, v58, v7
    v_mul_f32 v59, v59, v7
    v_cvt_pk_bf16_f32 v53, v58, v59
    v_mfma_f32_32x32x16_bf16 v[32:47], v[172:175], v[108:111], v[32:47]
    ds_read_b128 v[92:95], v1 offset:23552
    v_mul_f32 v60, v60, v7
    v_mul_f32 v61, v61, v7
    v_cvt_pk_bf16_f32 v54, v60, v61
    s_waitcnt lgkmcnt(10)
    v_mfma_f32_32x32x16_bf16 v[32:47], v[176:179], v[112:115], v[32:47]
    ds_read_b128 v[96:99], v1 offset:24576
    v_mul_f32 v62, v62, v7
    v_mul_f32 v63, v63, v7
    v_cvt_pk_bf16_f32 v55, v62, v63
    v_mfma_f32_32x32x16_bf16 v[32:47], v[180:183], v[116:119], v[32:47]
    ds_read_b128 v[100:103], v1 offset:25600
    s_waitcnt lgkmcnt(10)
    v_mfma_f32_32x32x16_bf16 v[32:47], v[184:187], v[120:123], v[32:47]
    ds_read_b128 v[104:107], v1 offset:26624
    buffer_store_dwordx4 v[48:51], v5, s[20:23], s35 offen nt
    buffer_store_dwordx4 v[52:55], v5, s[20:23], s35 offen offset:32 nt
    v_mfma_f32_32x32x16_bf16 v[32:47], v[188:191], v[124:127], v[32:47]
    ds_read_b128 v[108:111], v1 offset:27648
    s_waitcnt lgkmcnt(10)
    v_mfma_f32_32x32x16_bf16 v[32:47], v[192:195], v[64:67], v[32:47]
    ds_read_b128 v[112:115], v1 offset:28672
    s_waitcnt vmcnt(6)
    ds_write_b128 v4, v[24:27] offset:8448
    ds_write_b128 v4, v[28:31] offset:12672
    v_mfma_f32_32x32x16_bf16 v[32:47], v[196:199], v[68:71], v[32:47]
    ds_read_b128 v[116:119], v1 offset:29696
    s_waitcnt lgkmcnt(12)
    v_mfma_f32_32x32x16_bf16 v[32:47], v[200:203], v[72:75], v[32:47]
    ds_read_b128 v[120:123], v1 offset:30720
    v_mfma_f32_32x32x16_bf16 v[32:47], v[204:207], v[76:79], v[32:47]
    ds_read_b128 v[124:127], v1 offset:31744
    s_waitcnt lgkmcnt(12)
    v_mfma_f32_32x32x16_bf16 v[32:47], v[208:211], v[80:83], v[32:47]
    s_add_u32 s34, s34, 8192
    s_sub_u32 s31, s34, 147456
    s_cmp_ge_u32 s34, 147456
    s_cselect_b32 s34, s31, s34
    s_sub_u32 s48, s48, 1
    s_cmp_le_i32 s48, 0
    s_cselect_b32 s34, 147456, s34
    v_mfma_f32_32x32x16_bf16 v[32:47], v[212:215], v[84:87], v[32:47]
    s_add_u32 s35, s35, 8192
    s_sub_u32 s31, s35, 147456
    s_cmp_ge_u32 s35, 147456
    s_cselect_b32 s35, s31, s35
    s_waitcnt lgkmcnt(10)
    v_mfma_f32_32x32x16_bf16 v[32:47], v[216:219], v[88:91], v[32:47]
    v_mfma_f32_32x32x16_bf16 v[32:47], v[220:223], v[92:95], v[32:47]
    s_waitcnt lgkmcnt(0)
    s_barrier
    s_sub_u32 s26, s26, 1
    s_cmp_lg_u32 s26, 0
    s_cbranch_scc1 L_pv_loop
    v_mfma_f32_32x32x16_bf16 v[32:47], v[224:227], v[96:99], v[32:47]
    ds_read_b128 v[64:67], v1 offset:32768
    ds_read2_b32 v[8:9], v0 offset0:0 offset1:32
    ds_read2_b32 v[10:11], v0 offset0:64 offset1:96
    v_mfma_f32_32x32x16_bf16 v[32:47], v[228:231], v[100:103], v[32:47]
    ds_read_b128 v[68:71], v1 offset:33792
    ds_read2_b32 v[12:13], v0 offset0:128 offset1:160
    ds_read2_b32 v[14:15], v0 offset0:192 offset1:224
    v_mfma_f32_32x32x16_bf16 v[32:47], v[232:235], v[104:107], v[32:47]
    ds_read_b128 v[72:75], v1 offset:34816
    v_mfma_f32_32x32x16_bf16 v[32:47], v[236:239], v[108:111], v[32:47]
    ds_read_b128 v[76:79], v1 offset:35840
    v_mfma_f32_32x32x16_bf16 v[32:47], v[240:243], v[112:115], v[32:47]
    ds_read_b128 v[80:83], v1 offset:36864
    ds_read_b128 v[84:87], v1 offset:37888
    s_waitcnt lgkmcnt(4)
    v_add_f32 v8, v8, v9
    v_add_f32 v10, v10, v11
    v_add_f32 v12, v12, v13
    v_add_f32 v14, v14, v15
    v_mfma_f32_32x32x16_bf16 v[32:47], v[244:247], v[116:119], v[32:47]
    ds_read_b128 v[88:91], v1 offset:38912
    ds_read_b128 v[92:95], v1 offset:39936
    v_add_f32 v8, v8, v10
    v_add_f32 v12, v12, v14
    v_add_f32 v8, v8, v12
    v_rcp_f32 v7, v8
    v_mfma_f32_32x32x16_bf16 v[32:47], v[248:251], v[120:123], v[32:47]
    ds_read_b128 v[96:99], v1 offset:40960
    ds_read_b128 v[100:103], v1 offset:41984
    v_cmp_nle_f32 vcc, s46, v8
    v_cmp_nge_f32 s[30:31], s47, v8
    s_nop 1
    s_or_b64 vcc, vcc, s[30:31]
    s_cmp_lg_u64 vcc, 0
    s_cselect_b32 s30, 1, 0
    s_lshl_b32 s30, s30, s33
    s_or_b32 s27, s27, s30
    s_add_u32 s33, s33, 1
    s_cmp_eq_u32 s33, 18
    s_cselect_b32 s33, 0, s33
    v_mfma_f32_32x32x16_bf16 v[32:47], v[252:255], v[124:127], v[32:47]
    ds_read_b128 v[104:107], v1 offset:43008
    ds_read_b128 v[108:111], v1 offset:44032
    v_mfma_f32_32x32x16_bf16 v[48:63], v[128:131], v[64:67], 0
    ds_read_b128 v[112:115], v1 offset:45056
    v_mfma_f32_32x32x16_bf16 v[48:63], v[132:135], v[68:71], v[48:63]
    ds_read_b128 v[116:119], v1 offset:46080
    s_waitcnt lgkmcnt(10)
    v_mfma_f32_32x32x16_bf16 v[48:63], v[136:139], v[72:75], v[48:63]
    ds_read_b128 v[120:123], v1 offset:47104
    v_mfma_f32_32x32x16_bf16 v[48:63], v[140:143], v[76:79], v[48:63]
    ds_read_b128 v[124:127], v1 offset:48128
    s_waitcnt lgkmcnt(10)
    v_mfma_f32_32x32x16_bf16 v[48:63], v[144:147], v[80:83], v[48:63]
    ds_read_b128 v[64:67], v1 offset:49152
    v_mfma_f32_32x32x16_bf16 v[48:63], v[148:151], v[84:87], v[48:63]
    ds_read_b128 v[68:71], v1 offset:50176
    v_mul_f32 v32, v32, v6
    v_mul_f32 v33, v33, v6
    v_cvt_pk_bf16_f32 v32, v32, v33
    s_waitcnt lgkmcnt(10)
    v_mfma_f32_32x32x16_bf16 v[48:63], v[152:155], v[88:91], v[48:63]
    ds_read_b128 v[72:75], v1 offset:51200
    v_mul_f32 v34, v34, v6
    v_mul_f32 v35, v35, v6
    v_cvt_pk_bf16_f32 v33, v34, v35
    v_mfma_f32_32x32x16_bf16 v[48:63], v[156:159], v[92:95], v[48:63]
    ds_read_b128 v[76:79], v1 offset:52224
    v_mul_f32 v36, v36, v6
    v_mul_f32 v37, v37, v6
    v_cvt_pk_bf16_f32 v34, v36, v37
    s_waitcnt lgkmcnt(10)
    v_mfma_f32_32x32x16_bf16 v[48:63], v[160:163], v[96:99], v[48:63]
    ds_read_b128 v[80:83], v1 offset:53248
    v_mul_f32 v38, v38, v6
    v_mul_f32 v39, v39, v6
    v_cvt_pk_bf16_f32 v35, v38, v39
    v_mfma_f32_32x32x16_bf16 v[48:63], v[164:167], v[100:103], v[48:63]
    ds_read_b128 v[84:87], v1 offset:54272
    v_mul_f32 v40, v40, v6
    v_mul_f32 v41, v41, v6
    v_cvt_pk_bf16_f32 v36, v40, v41
    s_waitcnt lgkmcnt(10)
    v_mfma_f32_32x32x16_bf16 v[48:63], v[168:171], v[104:107], v[48:63]
    ds_read_b128 v[88:91], v1 offset:55296
    v_mul_f32 v42, v42, v6
    v_mul_f32 v43, v43, v6
    v_cvt_pk_bf16_f32 v37, v42, v43
    v_mfma_f32_32x32x16_bf16 v[48:63], v[172:175], v[108:111], v[48:63]
    ds_read_b128 v[92:95], v1 offset:56320
    v_mul_f32 v44, v44, v6
    v_mul_f32 v45, v45, v6
    v_cvt_pk_bf16_f32 v38, v44, v45
    s_waitcnt lgkmcnt(10)
    v_mfma_f32_32x32x16_bf16 v[48:63], v[176:179], v[112:115], v[48:63]
    ds_read_b128 v[96:99], v1 offset:57344
    v_mul_f32 v46, v46, v6
    v_mul_f32 v47, v47, v6
    v_cvt_pk_bf16_f32 v39, v46, v47
    v_mfma_f32_32x32x16_bf16 v[48:63], v[180:183], v[116:119], v[48:63]
    ds_read_b128 v[100:103], v1 offset:58368
    s_waitcnt lgkmcnt(10)
    v_mfma_f32_32x32x16_bf16 v[48:63], v[184:187], v[120:123], v[48:63]
    ds_read_b128 v[104:107], v1 offset:59392
    buffer_store_dwordx4 v[32:35], v5, s[20:23], s35 offen nt
    buffer_store_dwordx4 v[36:39], v5, s[20:23], s35 offen offset:32 nt
    v_mfma_f32_32x32x16_bf16 v[48:63], v[188:191], v[124:127], v[48:63]
    ds_read_b128 v[108:111], v1 offset:60416
    s_waitcnt lgkmcnt(10)
    v_mfma_f32_32x32x16_bf16 v[48:63], v[192:195], v[64:67], v[48:63]
    ds_read_b128 v[112:115], v1 offset:61440
    v_mfma_f32_32x32x16_bf16 v[48:63], v[196:199], v[68:71], v[48:63]
    ds_read_b128 v[116:119], v1 offset:62464
    s_waitcnt lgkmcnt(10)
    v_mfma_f32_32x32x16_bf16 v[48:63], v[200:203], v[72:75], v[48:63]
    ds_read_b128 v[120:123], v1 offset:63488
    v_mfma_f32_32x32x16_bf16 v[48:63], v[204:207], v[76:79], v[48:63]
    ds_read_b128 v[124:127], v1 offset:64512
    s_waitcnt lgkmcnt(10)
    v_mfma_f32_32x32x16_bf16 v[48:63], v[208:211], v[80:83], v[48:63]
    s_add_u32 s34, s34, 8192
    s_sub_u32 s31, s34, 147456
    s_cmp_ge_u32 s34, 147456
    s_cselect_b32 s34, s31, s34
    s_sub_u32 s48, s48, 1
    s_cmp_le_i32 s48, 0
    s_cselect_b32 s34, 147456, s34
    v_mfma_f32_32x32x16_bf16 v[48:63], v[212:215], v[84:87], v[48:63]
    s_add_u32 s35, s35, 8192
    s_sub_u32 s31, s35, 147456
    s_cmp_ge_u32 s35, 147456
    s_cselect_b32 s35, s31, s35
    s_waitcnt lgkmcnt(8)
    v_mfma_f32_32x32x16_bf16 v[48:63], v[216:219], v[88:91], v[48:63]
    v_mfma_f32_32x32x16_bf16 v[48:63], v[220:223], v[92:95], v[48:63]
    s_waitcnt lgkmcnt(0)
    v_mfma_f32_32x32x16_bf16 v[48:63], v[224:227], v[96:99], v[48:63]
    v_mfma_f32_32x32x16_bf16 v[48:63], v[228:231], v[100:103], v[48:63]
    v_mfma_f32_32x32x16_bf16 v[48:63], v[232:235], v[104:107], v[48:63]
    v_mfma_f32_32x32x16_bf16 v[48:63], v[236:239], v[108:111], v[48:63]
    v_mfma_f32_32x32x16_bf16 v[48:63], v[240:243], v[112:115], v[48:63]
    v_mfma_f32_32x32x16_bf16 v[48:63], v[244:247], v[116:119], v[48:63]
    v_mfma_f32_32x32x16_bf16 v[48:63], v[248:251], v[120:123], v[48:63]
    v_mfma_f32_32x32x16_bf16 v[48:63], v[252:255], v[124:127], v[48:63]
    s_nop 7
    s_nop 7
    v_mul_f32 v48, v48, v7
    v_mul_f32 v49, v49, v7
    v_cvt_pk_bf16_f32 v48, v48, v49
    v_mul_f32 v50, v50, v7
    v_mul_f32 v51, v51, v7
    v_cvt_pk_bf16_f32 v49, v50, v51
    v_mul_f32 v52, v52, v7
    v_mul_f32 v53, v53, v7
    v_cvt_pk_bf16_f32 v50, v52, v53
    v_mul_f32 v54, v54, v7
    v_mul_f32 v55, v55, v7
    v_cvt_pk_bf16_f32 v51, v54, v55
    v_mul_f32 v56, v56, v7
    v_mul_f32 v57, v57, v7
    v_cvt_pk_bf16_f32 v52, v56, v57
    v_mul_f32 v58, v58, v7
    v_mul_f32 v59, v59, v7
    v_cvt_pk_bf16_f32 v53, v58, v59
    v_mul_f32 v60, v60, v7
    v_mul_f32 v61, v61, v7
    v_cvt_pk_bf16_f32 v54, v60, v61
    v_mul_f32 v62, v62, v7
    v_mul_f32 v63, v63, v7
    v_cvt_pk_bf16_f32 v55, v62, v63
    buffer_store_dwordx4 v[48:51], v5, s[20:23], s35 offen nt
    buffer_store_dwordx4 v[52:55], v5, s[20:23], s35 offen offset:32 nt
    v_mov_b32 v8, 150016
    v_mov_b32 v9, s27
    ds_write_b32 v8, v9
    s_waitcnt lgkmcnt(0)
L_join:
    s_barrier
    v_mov_b32 v8, 150016
    ds_read_b32 v9, v8
    s_waitcnt lgkmcnt(0)
    v_readfirstlane_b32 s27, v9
    s_nop 3
    s_cmp_eq_u32 s27, 0
    s_cbranch_scc1 L_done
    s_waitcnt vmcnt(0)
    s_mov_b32 s44, 0
L_fb_loop:
    s_lshr_b32 s30, s27, s44
    s_and_b32 s30, s30, 1
    s_cmp_eq_u32 s30, 0
    s_cbranch_scc1 L_fb_next
    s_lshl_b32 s45, s44, 13
    s_cmp_ge_u32 s24, 4
    s_cbranch_scc1 L_fb_pv
    s_barrier
    ds_read_b128 v[32:35], v1 offset:0
    ds_read_b128 v[36:39], v1 offset:1056
    ds_read_b128 v[40:43], v1 offset:2112
    ds_read_b128 v[44:47], v1 offset:3168
    ds_read_b128 v[48:51], v1 offset:4224
    ds_read_b128 v[52:55], v1 offset:5280
    ds_read_b128 v[56:59], v1 offset:6336
    ds_read_b128 v[60:63], v1 offset:7392
    s_waitcnt lgkmcnt(0)
    v_mfma_f32_32x32x16_bf16 v[64:79], v[128:131], v[32:35], 0
    v_mfma_f32_32x32x16_bf16 v[64:79], v[132:135], v[36:39], v[64:79]
    v_mfma_f32_32x32x16_bf16 v[64:79], v[136:139], v[40:43], v[64:79]
    v_mfma_f32_32x32x16_bf16 v[64:79], v[140:143], v[44:47], v[64:79]
    v_mfma_f32_32x32x16_bf16 v[64:79], v[144:147], v[48:51], v[64:79]
    v_mfma_f32_32x32x16_bf16 v[64:79], v[148:151], v[52:55], v[64:79]
    v_mfma_f32_32x32x16_bf16 v[64:79], v[152:155], v[56:59], v[64:79]
    v_mfma_f32_32x32x16_bf16 v[64:79], v[156:159], v[60:63], v[64:79]
    v_mfma_f32_32x32x16_bf16 v[80:95], v[160:163], v[32:35], 0
    v_mfma_f32_32x32x16_bf16 v[80:95], v[164:167], v[36:39], v[80:95]
    v_mfma_f32_32x32x16_bf16 v[80:95], v[168:171], v[40:43], v[80:95]
    v_mfma_f32_32x32x16_bf16 v[80:95], v[172:175], v[44:47], v[80:95]
    v_mfma_f32_32x32x16_bf16 v[80:95], v[176:179], v[48:51], v[80:95]
    v_mfma_f32_32x32x16_bf16 v[80:95], v[180:183], v[52:55], v[80:95]
    v_mfma_f32_32x32x16_bf16 v[80:95], v[184:187], v[56:59], v[80:95]
    v_mfma_f32_32x32x16_bf16 v[80:95], v[188:191], v[60:63], v[80:95]
    v_mfma_f32_32x32x16_bf16 v[96:111], v[192:195], v[32:35], 0
    v_mfma_f32_32x32x16_bf16 v[96:111], v[196:199], v[36:39], v[96:111]
    v_mfma_f32_32x32x16_bf16 v[96:111], v[200:203], v[40:43], v[96:111]
    v_mfma_f32_32x32x16_bf16 v[96:111], v[204:207], v[44:47], v[96:111]
    v_mfma_f32_32x32x16_bf16 v[96:111], v[208:211], v[48:51], v[96:111]
    v_mfma_f32_32x32x16_bf16 v[96:111], v[212:215], v[52:55], v[96:111]
    v_mfma_f32_32x32x16_bf16 v[96:111], v[216:219], v[56:59], v[96:111]
    v_mfma_f32_32x32x16_bf16 v[96:111], v[220:223], v[60:63], v[96:111]
    v_mfma_f32_32x32x16_bf16 v[112:127], v[224:227], v[32:35], 0
    v_mfma_f32_32x32x16_bf16 v[112:127], v[228:231], v[36:39], v[112:127]
    v_mfma_f32_32x32x16_bf16 v[112:127], v[232:235], v[40:43], v[112:127]
    v_mfma_f32_32x32x16_bf16 v[112:127], v[236:239], v[44:47], v[112:127]
    v_mfma_f32_32x32x16_bf16 v[112:127], v[240:243], v[48:51], v[112:127]
    v_mfma_f32_32x32x16_bf16 v[112:127], v[244:247], v[52:55], v[112:127]
    v_mfma_f32_32x32x16_bf16 v[112:127], v[248:251], v[56:59], v[112:127]
    v_mfma_f32_32x32x16_bf16 v[112:127], v[252:255], v[60:63], v[112:127]
    s_nop 7
    s_nop 7
    v_max_f32 v6, v64, v65
    v_max3_f32 v6, v6, v66, v67
    v_max3_f32 v6, v6, v68, v69
    v_max3_f32 v6, v6, v70, v71
    v_max3_f32 v6, v6, v72, v73
    v_max3_f32 v6, v6, v74, v75
    v_max3_f32 v6, v6, v76, v77
    v_max3_f32 v6, v6, v78, v79
    v_max3_f32 v6, v6, v80, v81
    v_max3_f32 v6, v6, v82, v83
    v_max3_f32 v6, v6, v84, v85
    v_max3_f32 v6, v6, v86, v87
    v_max3_f32 v6, v6, v88, v89
    v_max3_f32 v6, v6, v90, v91
    v_max3_f32 v6, v6, v92, v93
    v_max3_f32 v6, v6, v94, v95
    v_max3_f32 v6, v6, v96, v97
    v_max3_f32 v6, v6, v98, v99
    v_max3_f32 v6, v6, v100, v101
    v_max3_f32 v6, v6, v102, v103
    v_max3_f32 v6, v6, v104, v105
    v_max3_f32 v6, v6, v106, v107
    v_max3_f32 v6, v6, v108, v109
    v_max3_f32 v6, v6, v110, v111
    v_max3_f32 v6, v6, v112, v113
    v_max3_f32 v6, v6, v114, v115
    v_max3_f32 v6, v6, v116, v117
    v_max3_f32 v6, v6, v118, v119
    v_max3_f32 v6, v6, v120, v121
    v_max3_f32 v6, v6, v122, v123
    v_max3_f32 v6, v6, v124, v125
    v_max3_f32 v6, v6, v126, v127
    v_mov_b32 v7, v6
    s_nop 1
    v_permlane32_swap_b32 v6, v7
    s_nop 1
    v_max_f32 v6, v6, v7
    v_lshlrev_b32 v8, 2, v0
    v_add_u32 v8, 150272, v8
    s_lshl_b32 s30, s25, 8
    v_add_u32 v9, s30, v8
    ds_write_b32 v9, v6
    s_waitcnt lgkmcnt(0)
    s_barrier
    ds_read_b32 v10, v8 offset:0
    ds_read_b32 v11, v8 offset:256
    ds_read_b32 v12, v8 offset:512
    ds_read_b32 v13, v8 offset:768
    s_waitcnt lgkmcnt(0)
    v_max3_f32 v6, v10, v11, v12
    v_max_f32 v6, v6, v13
    v_sub_f32 v64, v64, v6
    v_sub_f32 v65, v65, v6
    v_sub_f32 v66, v66, v6
    v_sub_f32 v67, v67, v6
    v_sub_f32 v68, v68, v6
    v_sub_f32 v69, v69, v6
    v_sub_f32 v70, v70, v6
    v_sub_f32 v71, v71, v6
    v_sub_f32 v72, v72, v6
    v_sub_f32 v73, v73, v6
    v_sub_f32 v74, v74, v6
    v_sub_f32 v75, v75, v6
    v_sub_f32 v76, v76, v6
    v_sub_f32 v77, v77, v6
    v_sub_f32 v78, v78, v6
    v_sub_f32 v79, v79, v6
    v_sub_f32 v80, v80, v6
    v_sub_f32 v81, v81, v6
    v_sub_f32 v82, v82, v6
    v_sub_f32 v83, v83, v6
    v_sub_f32 v84, v84, v6
    v_sub_f32 v85, v85, v6
    v_sub_f32 v86, v86, v6
    v_sub_f32 v87, v87, v6
    v_sub_f32 v88, v88, v6
    v_sub_f32 v89, v89, v6
    v_sub_f32 v90, v90, v6
    v_sub_f32 v91, v91, v6
    v_sub_f32 v92, v92, v6
    v_sub_f32 v93, v93, v6
    v_sub_f32 v94, v94, v6
    v_sub_f32 v95, v95, v6
    v_sub_f32 v96, v96, v6
    v_sub_f32 v97, v97, v6
    v_sub_f32 v98, v98, v6
    v_sub_f32 v99, v99, v6
    v_sub_f32 v100, v100, v6
    v_sub_f32 v101, v101, v6
    v_sub_f32 v102, v102, v6
    v_sub_f32 v103, v103, v6
    v_sub_f32 v104, v104, v6
    v_sub_f32 v105, v105, v6
    v_sub_f32 v106, v106, v6
    v_sub_f32 v107, v107, v6
    v_sub_f32 v108, v108, v6
    v_sub_f32 v109, v109, v6
    v_sub_f32 v110, v110, v6
    v_sub_f32 v111, v111, v6
    v_sub_f32 v112, v112, v6
    v_sub_f32 v113, v113, v6
    v_sub_f32 v114, v114, v6
    v_sub_f32 v115, v115, v6
    v_sub_f32 v116, v116, v6
    v_sub_f32 v117, v117, v6
    v_sub_f32 v118, v118, v6
    v_sub_f32 v119, v119, v6
    v_sub_f32 v120, v120, v6
    v_sub_f32 v121, v121, v6
    v_sub_f32 v122, v122, v6
    v_sub_f32 v123, v123, v6
    v_sub_f32 v124, v124, v6
    v_sub_f32 v125, v125, v6
    v_sub_f32 v126, v126, v6
    v_sub_f32 v127, v127, v6
    v_exp_f32 v64, v64
    v_exp_f32 v65, v65
    v_mov_b32 v4, v64
    v_mov_b32 v5, v65
    v_cvt_pk_bf16_f32 v16, v64, v65
    v_exp_f32 v66, v66
    v_exp_f32 v67, v67
    v_add_f32 v4, v4, v66
    v_add_f32 v5, v5, v67
    v_cvt_pk_bf16_f32 v17, v66, v67
    v_exp_f32 v68, v68
    v_exp_f32 v69, v69
    v_add_f32 v4, v4, v68
    v_add_f32 v5, v5, v69
    v_cvt_pk_bf16_f32 v18, v68, v69
    v_exp_f32 v70, v70
    v_exp_f32 v71, v71
    v_add_f32 v4, v4, v70
    v_add_f32 v5, v5, v71
    v_cvt_pk_bf16_f32 v19, v70, v71
    ds_write_b128 v2, v[16:19] offset:0
    v_exp_f32 v72, v72
    v_exp_f32 v73, v73
    v_add_f32 v4, v4, v72
    v_add_f32 v5, v5, v73
    v_cvt_pk_bf16_f32 v20, v72, v73
    v_exp_f32 v74, v74
    v_exp_f32 v75, v75
    v_add_f32 v4, v4, v74
    v_add_f32 v5, v5, v75
    v_cvt_pk_bf16_f32 v21, v74, v75
    v_exp_f32 v76, v76
    v_exp_f32 v77, v77
    v_add_f32 v4, v4, v76
    v_add_f32 v5, v5, v77
    v_cvt_pk_bf16_f32 v22, v76, v77
    v_exp_f32 v78, v78
    v_exp_f32 v79, v79
    v_add_f32 v4, v4, v78
    v_add_f32 v5, v5, v79
    v_cvt_pk_bf16_f32 v23, v78, v79
    ds_write_b128 v2, v[20:23] offset:1024
    v_exp_f32 v80, v80
    v_exp_f32 v81, v81
    v_add_f32 v4, v4, v80
    v_add_f32 v5, v5, v81
    v_cvt_pk_bf16_f32 v24, v80, v81
    v_exp_f32 v82, v82
    v_exp_f32 v83, v83
    v_add_f32 v4, v4, v82
    v_add_f32 v5, v5, v83
    v_cvt_pk_bf16_f32 v25, v82, v83
    v_exp_f32 v84, v84
    v_exp_f32 v85, v85
    v_add_f32 v4, v4, v84
    v_add_f32 v5, v5, v85
    v_cvt_pk_bf16_f32 v26, v84, v85
    v_exp_f32 v86, v86
    v_exp_f32 v87, v87
    v_add_f32 v4, v4, v86
    v_add_f32 v5, v5, v87
    v_cvt_pk_bf16_f32 v27, v86, v87
    ds_write_b128 v2, v[24:27] offset:2048
    v_exp_f32 v88, v88
    v_exp_f32 v89, v89
    v_add_f32 v4, v4, v88
    v_add_f32 v5, v5, v89
    v_cvt_pk_bf16_f32 v28, v88, v89
    v_exp_f32 v90, v90
    v_exp_f32 v91, v91
    v_add_f32 v4, v4, v90
    v_add_f32 v5, v5, v91
    v_cvt_pk_bf16_f32 v29, v90, v91
    v_exp_f32 v92, v92
    v_exp_f32 v93, v93
    v_add_f32 v4, v4, v92
    v_add_f32 v5, v5, v93
    v_cvt_pk_bf16_f32 v30, v92, v93
    v_exp_f32 v94, v94
    v_exp_f32 v95, v95
    v_add_f32 v4, v4, v94
    v_add_f32 v5, v5, v95
    v_cvt_pk_bf16_f32 v31, v94, v95
    ds_write_b128 v2, v[28:31] offset:3072
    v_exp_f32 v96, v96
    v_exp_f32 v97, v97
    v_add_f32 v4, v4, v96
    v_add_f32 v5, v5, v97
    v_cvt_pk_bf16_f32 v16, v96, v97
    v_exp_f32 v98, v98
    v_exp_f32 v99, v99
    v_add_f32 v4, v4, v98
    v_add_f32 v5, v5, v99
    v_cvt_pk_bf16_f32 v17, v98, v99
    v_exp_f32 v100, v100
    v_exp_f32 v101, v101
    v_add_f32 v4, v4, v100
    v_add_f32 v5, v5, v101
    v_cvt_pk_bf16_f32 v18, v100, v101
    v_exp_f32 v102, v102
    v_exp_f32 v103, v103
    v_add_f32 v4, v4, v102
    v_add_f32 v5, v5, v103
    v_cvt_pk_bf16_f32 v19, v102, v103
    ds_write_b128 v2, v[16:19] offset:4096
    v_exp_f32 v104, v104
    v_exp_f32 v105, v105
    v_add_f32 v4, v4, v104
    v_add_f32 v5, v5, v105
    v_cvt_pk_bf16_f32 v20, v104, v105
    v_exp_f32 v106, v106
    v_exp_f32 v107, v107
    v_add_f32 v4, v4, v106
    v_add_f32 v5, v5, v107
    v_cvt_pk_bf16_f32 v21, v106, v107
    v_exp_f32 v108, v108
    v_exp_f32 v109, v109
    v_add_f32 v4, v4, v108
    v_add_f32 v5, v5, v109
    v_cvt_pk_bf16_f32 v22, v108, v109
    v_exp_f32 v110, v110
    v_exp_f32 v111, v111
    v_add_f32 v4, v4, v110
    v_add_f32 v5, v5, v111
    v_cvt_pk_bf16_f32 v23, v110, v111
    ds_write_b128 v2, v[20:23] offset:5120
    v_exp_f32 v112, v112
    v_exp_f32 v113, v113
    v_add_f32 v4, v4, v112
    v_add_f32 v5, v5, v113
    v_cvt_pk_bf16_f32 v24, v112, v113
    v_exp_f32 v114, v114
    v_exp_f32 v115, v115
    v_add_f32 v4, v4, v114
    v_add_f32 v5, v5, v115
    v_cvt_pk_bf16_f32 v25, v114, v115
    v_exp_f32 v116, v116
    v_exp_f32 v117, v117
    v_add_f32 v4, v4, v116
    v_add_f32 v5, v5, v117
    v_cvt_pk_bf16_f32 v26, v116, v117
    v_exp_f32 v118, v118
    v_exp_f32 v119, v119
    v_add_f32 v4, v4, v118
    v_add_f32 v5, v5, v119
    v_cvt_pk_bf16_f32 v27, v118, v119
    ds_write_b128 v2, v[24:27] offset:6144
    v_exp_f32 v120, v120
    v_exp_f32 v121, v121
    v_add_f32 v4, v4, v120
    v_add_f32 v5, v5, v121
    v_cvt_pk_bf16_f32 v28, v120, v121
    v_exp_f32 v122, v122
    v_exp_f32 v123, v123
    v_add_f32 v4, v4, v122
    v_add_f32 v5, v5, v123
    v_cvt_pk_bf16_f32 v29, v122, v123
    v_exp_f32 v124, v124
    v_exp_f32 v125, v125
    v_add_f32 v4, v4, v124
    v_add_f32 v5, v5, v125
    v_cvt_pk_bf16_f32 v30, v124, v125
    v_exp_f32 v126, v126
    v_exp_f32 v127, v127
    v_add_f32 v4, v4, v126
    v_add_f32 v5, v5, v127
    v_cvt_pk_bf16_f32 v31, v126, v127
    ds_write_b128 v2, v[28:31] offset:7168
    v_add_f32 v6, v4, v5
    ds_write_b32 v3, v6 offset:0
    s_waitcnt lgkmcnt(0)
    s_barrier
    s_branch L_fb_next
L_fb_pv:
    buffer_load_dwordx4 v[16:19], v3, s[12:15], s45 offen
    buffer_load_dwordx4 v[20:23], v3, s[12:15], s45 offen offset:128
    s_waitcnt vmcnt(0)
    ds_write_b128 v4, v[16:19]
    ds_write_b128 v4, v[20:23] offset:4224
    s_waitcnt lgkmcnt(0)
    s_barrier
    s_barrier
    s_barrier
    ds_read2_b32 v[8:9], v2 offset0:0 offset1:32
    ds_read2_b32 v[10:11], v2 offset0:64 offset1:96
    ds_read2_b32 v[12:13], v2 offset0:128 offset1:160
    ds_read2_b32 v[14:15], v2 offset0:192 offset1:224
    s_waitcnt lgkmcnt(0)
    v_add_f32 v8, v8, v9
    v_add_f32 v10, v10, v11
    v_add_f32 v12, v12, v13
    v_add_f32 v14, v14, v15
    v_add_f32 v8, v8, v10
    v_add_f32 v12, v12, v14
    v_add_f32 v8, v8, v12
    v_rcp_f32 v6, v8
    ds_read_b128 v[64:67], v1 offset:0
    ds_read_b128 v[68:71], v1 offset:1024
    ds_read_b128 v[72:75], v1 offset:2048
    ds_read_b128 v[76:79], v1 offset:3072
    ds_read_b128 v[80:83], v1 offset:4096
    ds_read_b128 v[84:87], v1 offset:5120
    ds_read_b128 v[88:91], v1 offset:6144
    ds_read_b128 v[92:95], v1 offset:7168
    s_waitcnt lgkmcnt(0)
    v_mfma_f32_32x32x16_bf16 v[32:47], v[128:131], v[64:67], 0
    v_mfma_f32_32x32x16_bf16 v[32:47], v[132:135], v[68:71], v[32:47]
    v_mfma_f32_32x32x16_bf16 v[32:47], v[136:139], v[72:75], v[32:47]
    v_mfma_f32_32x32x16_bf16 v[32:47], v[140:143], v[76:79], v[32:47]
    v_mfma_f32_32x32x16_bf16 v[32:47], v[144:147], v[80:83], v[32:47]
    v_mfma_f32_32x32x16_bf16 v[32:47], v[148:151], v[84:87], v[32:47]
    v_mfma_f32_32x32x16_bf16 v[32:47], v[152:155], v[88:91], v[32:47]
    v_mfma_f32_32x32x16_bf16 v[32:47], v[156:159], v[92:95], v[32:47]
    s_nop 7
    ds_read_b128 v[64:67], v1 offset:8192
    ds_read_b128 v[68:71], v1 offset:9216
    ds_read_b128 v[72:75], v1 offset:10240
    ds_read_b128 v[76:79], v1 offset:11264
    ds_read_b128 v[80:83], v1 offset:12288
    ds_read_b128 v[84:87], v1 offset:13312
    ds_read_b128 v[88:91], v1 offset:14336
    ds_read_b128 v[92:95], v1 offset:15360
    s_waitcnt lgkmcnt(0)
    v_mfma_f32_32x32x16_bf16 v[32:47], v[160:163], v[64:67], v[32:47]
    v_mfma_f32_32x32x16_bf16 v[32:47], v[164:167], v[68:71], v[32:47]
    v_mfma_f32_32x32x16_bf16 v[32:47], v[168:171], v[72:75], v[32:47]
    v_mfma_f32_32x32x16_bf16 v[32:47], v[172:175], v[76:79], v[32:47]
    v_mfma_f32_32x32x16_bf16 v[32:47], v[176:179], v[80:83], v[32:47]
    v_mfma_f32_32x32x16_bf16 v[32:47], v[180:183], v[84:87], v[32:47]
    v_mfma_f32_32x32x16_bf16 v[32:47], v[184:187], v[88:91], v[32:47]
    v_mfma_f32_32x32x16_bf16 v[32:47], v[188:191], v[92:95], v[32:47]
    s_nop 7
    ds_read_b128 v[64:67], v1 offset:16384
    ds_read_b128 v[68:71], v1 offset:17408
    ds_read_b128 v[72:75], v1 offset:18432
    ds_read_b128 v[76:79], v1 offset:19456
    ds_read_b128 v[80:83], v1 offset:20480
    ds_read_b128 v[84:87], v1 offset:21504
    ds_read_b128 v[88:91], v1 offset:22528
    ds_read_b128 v[92:95], v1 offset:23552
    s_waitcnt lgkmcnt(0)
    v_mfma_f32_32x32x16_bf16 v[32:47], v[192:195], v[64:67], v[32:47]
    v_mfma_f32_32x32x16_bf16 v[32:47], v[196:199], v[68:71], v[32:47]
    v_mfma_f32_32x32x16_bf16 v[32:47], v[200:203], v[72:75], v[32:47]
    v_mfma_f32_32x32x16_bf16 v[32:47], v[204:207], v[76:79], v[32:47]
    v_mfma_f32_32x32x16_bf16 v[32:47], v[208:211], v[80:83], v[32:47]
    v_mfma_f32_32x32x16_bf16 v[32:47], v[212:215], v[84:87], v[32:47]
    v_mfma_f32_32x32x16_bf16 v[32:47], v[216:219], v[88:91], v[32:47]
    v_mfma_f32_32x32x16_bf16 v[32:47], v[220:223], v[92:95], v[32:47]
    s_nop 7
    ds_read_b128 v[64:67], v1 offset:24576
    ds_read_b128 v[68:71], v1 offset:25600
    ds_read_b128 v[72:75], v1 offset:26624
    ds_read_b128 v[76:79], v1 offset:27648
    ds_read_b128 v[80:83], v1 offset:28672
    ds_read_b128 v[84:87], v1 offset:29696
    ds_read_b128 v[88:91], v1 offset:30720
    ds_read_b128 v[92:95], v1 offset:31744
    s_waitcnt lgkmcnt(0)
    v_mfma_f32_32x32x16_bf16 v[32:47], v[224:227], v[64:67], v[32:47]
    v_mfma_f32_32x32x16_bf16 v[32:47], v[228:231], v[68:71], v[32:47]
    v_mfma_f32_32x32x16_bf16 v[32:47], v[232:235], v[72:75], v[32:47]
    v_mfma_f32_32x32x16_bf16 v[32:47], v[236:239], v[76:79], v[32:47]
    v_mfma_f32_32x32x16_bf16 v[32:47], v[240:243], v[80:83], v[32:47]
    v_mfma_f32_32x32x16_bf16 v[32:47], v[244:247], v[84:87], v[32:47]
    v_mfma_f32_32x32x16_bf16 v[32:47], v[248:251], v[88:91], v[32:47]
    v_mfma_f32_32x32x16_bf16 v[32:47], v[252:255], v[92:95], v[32:47]
    s_nop 7
    s_nop 7
    s_nop 7
    v_mul_f32 v32, v32, v6
    v_mul_f32 v33, v33, v6
    v_cvt_pk_bf16_f32 v32, v32, v33
    v_mul_f32 v34, v34, v6
    v_mul_f32 v35, v35, v6
    v_cvt_pk_bf16_f32 v33, v34, v35
    v_mul_f32 v36, v36, v6
    v_mul_f32 v37, v37, v6
    v_cvt_pk_bf16_f32 v34, v36, v37
    v_mul_f32 v38, v38, v6
    v_mul_f32 v39, v39, v6
    v_cvt_pk_bf16_f32 v35, v38, v39
    v_mul_f32 v40, v40, v6
    v_mul_f32 v41, v41, v6
    v_cvt_pk_bf16_f32 v36, v40, v41
    v_mul_f32 v42, v42, v6
    v_mul_f32 v43, v43, v6
    v_cvt_pk_bf16_f32 v37, v42, v43
    v_mul_f32 v44, v44, v6
    v_mul_f32 v45, v45, v6
    v_cvt_pk_bf16_f32 v38, v44, v45
    v_mul_f32 v46, v46, v6
    v_mul_f32 v47, v47, v6
    v_cvt_pk_bf16_f32 v39, v46, v47
    buffer_store_dwordx4 v[32:35], v5, s[20:23], s45 offen
    buffer_store_dwordx4 v[36:39], v5, s[20:23], s45 offen offset:32
    s_waitcnt vmcnt(0)
L_fb_next:
    s_add_u32 s44, s44, 1
    s_cmp_lt_u32 s44, 18
    s_cbranch_scc1 L_fb_loop
L_done:
    s_waitcnt vmcnt(0)
L_end:
    s_endpgm
.section .rodata,"a"
.p2align 6
.amdhsa_kernel standalone__gqa_softmax__near_ridge_kernel
  .amdhsa_next_free_vgpr 256
  .amdhsa_next_free_sgpr 64
  .amdhsa_accum_offset 256
  .amdhsa_group_segment_fixed_size 0
  .amdhsa_kernarg_size 48
  .amdhsa_user_sgpr_count 2
  .amdhsa_user_sgpr_kernarg_segment_ptr 1
  .amdhsa_system_sgpr_workgroup_id_x 1
.end_amdhsa_kernel
```
